```python
import torch

def _softmax(x, axis=-1):
    return torch.softmax(x, dim=axis)
def _gelu(x):
    return torch.nn.functional.gelu(x, approximate="tanh")
def _silu(x):
    return torch.nn.functional.silu(x)
def _sigmoid(x):
    return torch.sigmoid(x)
def _layernorm(x, axis=-1, eps=1e-5):
    m = x.mean(dim=axis, keepdim=True)
    v = x.var(dim=axis, keepdim=True, unbiased=False)
    return (x - m) / torch.sqrt(v + eps)
def _scatter_add(tgt, idx, src, axis=0):
    return tgt.clone().index_add_(axis, idx, src)
def _segment_sum(src, seg, n):
    out = torch.zeros((n,) + src.shape[1:], dtype=src.dtype)
    return out.index_add_(0, seg, src)
def _pad(x, pw):
    flat = tuple(v for pair in reversed(pw) for v in pair)
    return torch.nn.functional.pad(x, flat)

kernel_name = 'recurrent_scan__gqa_block_cached__glu_gated_glu__decode'

def setup_inputs():

    _w = (lambda a: (lambda t: t.to(torch.bfloat16) if t.is_floating_point() else t)(torch.as_tensor(a)))
    def _A_setup():
        B, Sq, D = 8, 1, 1024
        Hq, Hkv, Sk, Dh = 32, 4, 4096, 128
        assert Hq % Hkv == 0, (Hq, Hkv)
        return {
            "x": _w((lambda *s: torch.randn(*s, dtype=torch.bfloat16) * 0.05)(B, Sq, D)),
            "k_cache": _w((lambda *s: torch.randn(*s, dtype=torch.bfloat16) * 1.6)(B, Hkv, Sk, Dh)),
            "v_cache": _w((lambda *s: torch.randn(*s, dtype=torch.bfloat16) * 0.2)(B, Hkv, Sk, Dh)),
            "wq": _w((lambda *s: torch.randn(*s, dtype=torch.bfloat16) * 1.6)(D, Hq * Dh) * (D ** -0.5)),
            "wo": _w((lambda *s: torch.randn(*s, dtype=torch.bfloat16) * 0.2)(Hq * Dh, D) * ((Hq * Dh) ** -0.5)),
        }
    _A_in = _A_setup()

    def _B_setup():
        B, S, D, F = 8, 1, 1024, 3584
        return {
            "x": _w((lambda *s: torch.randn(*s, dtype=torch.bfloat16) * 0.05)(B, S, D)),
            "w_gate": _w((lambda *s: torch.randn(*s, dtype=torch.bfloat16) * 0.2)(D, F)),
            "w_up": _w((lambda *s: torch.randn(*s, dtype=torch.bfloat16) * 0.1)(D, F)),
            "w_down": _w((lambda *s: torch.randn(*s, dtype=torch.bfloat16) * 0.1)(F, D)),
        }
    _B_in = _B_setup()

    return {
        "A_x": _A_in["x"],
        "A_k_cache": _A_in["k_cache"],
        "A_v_cache": _A_in["v_cache"],
        "A_wq": _A_in["wq"],
        "A_wo": _A_in["wo"],
        "B_x": _B_in["x"],
        "B_w_gate": _B_in["w_gate"],
        "B_w_up": _B_in["w_up"],
        "B_w_down": _B_in["w_down"],
    }

def reference(A_x, A_k_cache, A_v_cache, A_wq, A_wo, B_x, B_w_gate, B_w_up, B_w_down):
    def _A_ref(x, k_cache, v_cache, wq, wo):
        B, Sq, D = x.shape
        Hq, Dh = 32, 128
        Hkv = k_cache.shape[1]
        rep = Hq // Hkv
        q = (lambda x, *d: x.permute(*d))((x @ wq).reshape(B, Sq, Hq, Dh), 0, 2, 1, 3)
        k = (lambda x, n, axis: torch.repeat_interleave(x, n, dim=axis))(k_cache, rep, axis=1)
        v = (lambda x, n, axis: torch.repeat_interleave(x, n, dim=axis))(v_cache, rep, axis=1)
        scores = torch.einsum("bhqd,bhkd->bhqk", q, k) * (Dh ** -0.5)
        p = _softmax(scores, axis=-1)
        o = torch.einsum("bhqk,bhkd->bhqd", p, v)
        return (lambda x, *d: x.permute(*d))(o, 0, 2, 1, 3).reshape(B, Sq, Hq * Dh) @ wo

    def _B_ref(x, w_gate, w_up, w_down):
        g = torch.einsum("bsd,df->bsf", x, w_gate)
        u = torch.einsum("bsd,df->bsf", x, w_up)
        h = _sigmoid(g) * u
        return torch.einsum("bsf,fd->bsd", h, w_down)

    x = A_x
    xn = _layernorm(x, axis=-1)
    s = _A_ref(xn, A_k_cache, A_v_cache, A_wq, A_wo)
    g = _silu(_B_ref(xn, B_w_gate, B_w_up, B_w_down))
    return x + s * g
```

```asm
; @launch grid=(256,1,1) block=(512,1,1) lds=94208
.amdgcn_target "amdgcn-amd-amdhsa--gfx950"
.text
.globl recurrent_scan__gqa_block_cached__glu_gated_glu__decode_kernel
.p2align 8
.type recurrent_scan__gqa_block_cached__glu_gated_glu__decode_kernel,@function
recurrent_scan__gqa_block_cached__glu_gated_glu__decode_kernel:
    s_cmp_ge_u32 s2, 256
    s_cbranch_scc1 L_end
    s_load_dwordx16 s[16:31], s[0:1], 0
    s_load_dwordx8 s[32:39], s[0:1], 64
    v_lshrrev_b32 v1, 6, v0
    v_and_b32 v0, 63, v0
    s_nop 0
    v_readfirstlane_b32 s76, v1
    s_mov_b32 s78, 0x05040100
    s_mov_b32 s79, 0x07060302
    s_and_b32 s80, s2, 3
    s_lshr_b32 s81, s2, 2
    s_nop 3
    s_and_b32 s100, s76, 3
    v_lshrrev_b32 v1, 4, v0
    v_and_b32 v2, 7, v0
    v_bfe_u32 v3, v0, 3, 1
    v_and_b32 v9, 15, v0
    v_lshlrev_b32 v11, 5, v3
    v_lshl_add_u32 v11, v1, 3, v11
    v_lshlrev_b32 v10, 5, v0
    v_lshlrev_b32 v4, 8, v9
    v_lshl_add_u32 v4, v1, 4, v4
    v_lshlrev_b32 v5, 10, v1
    v_lshl_add_u32 v5, v9, 4, v5
    v_lshlrev_b32 v6, 13, v11
    v_lshl_add_u32 v6, v2, 4, v6
    v_mul_u32_u24 v7, 7168, v11
    v_lshl_add_u32 v7, v2, 4, v7
    v_lshrrev_b32 v8, 1, v1
    v_cmp_eq_u32 s[96:97], v3, v8
    v_cmp_eq_u32 s[98:99], 0, v3
    s_lshl_b32 s101, s76, 11
    s_waitcnt lgkmcnt(0)
    s_mov_b32 s60, s16
    s_and_b32 s61, s17, 0xffff
    s_mov_b32 s62, 16384
    s_mov_b32 s63, 0x20000
    buffer_load_dwordx4 v[16:19], v10, s[60:63], s101 offen
    buffer_load_dwordx4 v[20:23], v10, s[60:63], s101 offen offset:16
    s_mov_b32 s64, s38
    s_and_b32 s65, s39, 0xffff
    s_mov_b32 s66, 268435456
    s_mov_b32 s67, 0x20000
    s_mov_b32 s68, s36
    s_and_b32 s69, s37, 0xffff
    s_mov_b32 s70, 256
    s_mov_b32 s71, 0x20000
    s_mov_b32 s72, s34
    s_and_b32 s73, s35, 0xffff
    s_mov_b32 s74, 16384
    s_mov_b32 s75, 0x20000
    s_mov_b32 s40, s18
    s_and_b32 s41, s19, 0xffff
    s_mov_b32 s42, 33554432
    s_mov_b32 s43, 0x20000
    s_mov_b32 s44, s20
    s_and_b32 s45, s21, 0xffff
    s_mov_b32 s46, 33554432
    s_mov_b32 s47, 0x20000
    s_lshl_b32 s89, s2, 17
    s_lshl_b32 s83, s76, 14
    s_add_u32 s89, s89, s83
    s_lshr_b32 s90, s2, 3
    s_lshl_b32 s90, s90, 18
    s_and_b32 s83, s2, 7
    s_lshl_b32 s83, s83, 8
    s_add_u32 s90, s90, s83
    s_lshl_b32 s83, s100, 16
    s_add_u32 s90, s90, s83
    s_cmp_ge_u32 s76, 4
    s_cbranch_scc1 L_g1
    s_mov_b32 s48, s22
    s_and_b32 s49, s23, 0xffff
    s_mov_b32 s50, 8388608
    s_mov_b32 s51, 0x20000
    s_mov_b32 s52, s28
    s_and_b32 s53, s29, 0xffff
    s_mov_b32 s54, 7340032
    s_mov_b32 s55, 0x20000
    s_mov_b32 s56, s32
    s_and_b32 s57, s33, 0xffff
    s_mov_b32 s58, 7340032
    s_mov_b32 s59, 0x20000
    s_cmp_ge_u32 s2, 224
    s_cselect_b32 s54, 0, s54
    s_cselect_b32 s58, 0, s58
    s_lshl_b32 s82, s80, 8
    s_lshl_b32 s83, s100, 6
    s_add_u32 s82, s82, s83
    s_lshl_b32 s84, s81, 7
    s_lshl_b32 s16, s82, 13
    s_add_u32 s16, s16, s84
    s_add_u32 s84, s81, 2
    s_and_b32 s84, s84, 7
    s_and_b32 s85, s81, 0xf8
    s_or_b32 s84, s84, s85
    s_lshl_b32 s84, s84, 7
    s_mul_i32 s17, s82, 7168
    s_add_u32 s17, s17, s84
    s_lshr_b32 s18, s2, 5
    s_lshl_b32 s18, s18, 14
    s_lshr_b32 s87, s2, 3
    s_and_b32 s87, s87, 3
    s_lshl_b32 s87, s87, 12
    s_add_u32 s18, s18, s87
    buffer_load_dwordx4 v[64:67], v6, s[48:51], s16 offen offset:0 nt
    s_add_u32 s77, s16, 8192
    buffer_load_dwordx4 v[68:71], v6, s[48:51], s77 offen offset:0 nt
    s_add_u32 s77, s16, 16384
    buffer_load_dwordx4 v[72:75], v6, s[48:51], s77 offen offset:0 nt
    s_add_u32 s77, s16, 24576
    buffer_load_dwordx4 v[76:79], v6, s[48:51], s77 offen offset:0 nt
    s_add_u32 s77, s16, 32768
    buffer_load_dwordx4 v[80:83], v6, s[48:51], s77 offen offset:0 nt
    s_add_u32 s77, s16, 40960
    buffer_load_dwordx4 v[84:87], v6, s[48:51], s77 offen offset:0 nt
    s_waitcnt vmcnt(6)
    v_lshlrev_b32 v32, 16, v16
    v_and_b32 v33, 0xffff0000, v16
    v_lshlrev_b32 v34, 16, v17
    v_and_b32 v35, 0xffff0000, v17
    v_lshlrev_b32 v36, 16, v18
    v_and_b32 v37, 0xffff0000, v18
    v_lshlrev_b32 v38, 16, v19
    v_and_b32 v39, 0xffff0000, v19
    v_lshlrev_b32 v40, 16, v20
    v_and_b32 v41, 0xffff0000, v20
    v_lshlrev_b32 v42, 16, v21
    v_and_b32 v43, 0xffff0000, v21
    v_lshlrev_b32 v44, 16, v22
    v_and_b32 v45, 0xffff0000, v22
    v_lshlrev_b32 v46, 16, v23
    v_and_b32 v47, 0xffff0000, v23
    v_add_f32 v8, v32, v33
    v_add_f32 v8, v8, v34
    v_add_f32 v8, v8, v35
    v_add_f32 v8, v8, v36
    v_add_f32 v8, v8, v37
    v_add_f32 v8, v8, v38
    v_add_f32 v8, v8, v39
    v_add_f32 v8, v8, v40
    v_add_f32 v8, v8, v41
    v_add_f32 v8, v8, v42
    v_add_f32 v8, v8, v43
    v_add_f32 v8, v8, v44
    v_add_f32 v8, v8, v45
    v_add_f32 v8, v8, v46
    v_add_f32 v8, v8, v47
    s_nop 1
    v_add_f32_dpp v8, v8, v8 quad_perm:[1,0,3,2] row_mask:0xf bank_mask:0xf
    s_nop 1
    v_add_f32_dpp v8, v8, v8 quad_perm:[2,3,0,1] row_mask:0xf bank_mask:0xf
    s_nop 1
    v_add_f32_dpp v8, v8, v8 row_half_mirror row_mask:0xf bank_mask:0xf
    s_nop 1
    v_add_f32_dpp v8, v8, v8 row_mirror row_mask:0xf bank_mask:0xf
    v_mov_b32 v9, v8
    s_nop 1
    v_permlane16_swap_b32 v8, v9
    s_nop 1
    v_add_f32 v8, v8, v9
    v_mov_b32 v9, v8
    s_nop 1
    v_permlane32_swap_b32 v8, v9
    s_nop 1
    v_add_f32 v8, v8, v9
    v_mul_f32 v8, 0x3a800000, v8
    v_mov_b32 v13, 0
    v_sub_f32 v9, v32, v8
    v_fmac_f32 v13, v9, v9
    v_sub_f32 v9, v33, v8
    v_fmac_f32 v13, v9, v9
    v_sub_f32 v9, v34, v8
    v_fmac_f32 v13, v9, v9
    v_sub_f32 v9, v35, v8
    v_fmac_f32 v13, v9, v9
    v_sub_f32 v9, v36, v8
    v_fmac_f32 v13, v9, v9
    v_sub_f32 v9, v37, v8
    v_fmac_f32 v13, v9, v9
    v_sub_f32 v9, v38, v8
    v_fmac_f32 v13, v9, v9
    v_sub_f32 v9, v39, v8
    v_fmac_f32 v13, v9, v9
    v_sub_f32 v9, v40, v8
    v_fmac_f32 v13, v9, v9
    v_sub_f32 v9, v41, v8
    v_fmac_f32 v13, v9, v9
    v_sub_f32 v9, v42, v8
    v_fmac_f32 v13, v9, v9
    v_sub_f32 v9, v43, v8
    v_fmac_f32 v13, v9, v9
    v_sub_f32 v9, v44, v8
    v_fmac_f32 v13, v9, v9
    v_sub_f32 v9, v45, v8
    v_fmac_f32 v13, v9, v9
    v_sub_f32 v9, v46, v8
    v_fmac_f32 v13, v9, v9
    v_sub_f32 v9, v47, v8
    v_fmac_f32 v13, v9, v9
    s_nop 1
    v_add_f32_dpp v13, v13, v13 quad_perm:[1,0,3,2] row_mask:0xf bank_mask:0xf
    s_nop 1
    v_add_f32_dpp v13, v13, v13 quad_perm:[2,3,0,1] row_mask:0xf bank_mask:0xf
    s_nop 1
    v_add_f32_dpp v13, v13, v13 row_half_mirror row_mask:0xf bank_mask:0xf
    s_nop 1
    v_add_f32_dpp v13, v13, v13 row_mirror row_mask:0xf bank_mask:0xf
    v_mov_b32 v9, v13
    s_nop 1
    v_permlane16_swap_b32 v13, v9
    s_nop 1
    v_add_f32 v13, v13, v9
    v_mov_b32 v9, v13
    s_nop 1
    v_permlane32_swap_b32 v13, v9
    s_nop 1
    v_add_f32 v13, v13, v9
    v_mul_f32 v13, 0x3a800000, v13
    v_cvt_pk_bf16_f32 v12, v8, v13
    v_lshlrev_b32 v8, 16, v12
    v_and_b32 v13, 0xffff0000, v12
    v_add_f32 v13, 0x3727c5ac, v13
    v_cvt_pk_bf16_f32 v13, v13, v13
    v_and_b32 v13, 0xffff0000, v13
    v_sqrt_f32 v13, v13
    s_nop 0
    v_cvt_pk_bf16_f32 v13, v13, v13
    v_and_b32 v13, 0xffff0000, v13
    v_rcp_f32 v12, v13
    s_nop 0
    v_fma_f32 v9, -v13, v12, 1.0
    v_fma_f32 v12, v9, v12, v12
    v_sub_f32 v32, v32, v8
    v_sub_f32 v33, v33, v8
    v_cvt_pk_bf16_f32 v9, v32, v33
    v_lshlrev_b32 v32, 16, v9
    v_and_b32 v33, 0xffff0000, v9
    v_mul_f32 v32, v32, v12
    v_mul_f32 v33, v33, v12
    v_cvt_pk_bf16_f32 v16, v32, v33
    v_sub_f32 v34, v34, v8
    v_sub_f32 v35, v35, v8
    v_cvt_pk_bf16_f32 v9, v34, v35
    v_lshlrev_b32 v34, 16, v9
    v_and_b32 v35, 0xffff0000, v9
    v_mul_f32 v34, v34, v12
    v_mul_f32 v35, v35, v12
    v_cvt_pk_bf16_f32 v17, v34, v35
    v_sub_f32 v36, v36, v8
    v_sub_f32 v37, v37, v8
    v_cvt_pk_bf16_f32 v9, v36, v37
    v_lshlrev_b32 v36, 16, v9
    v_and_b32 v37, 0xffff0000, v9
    v_mul_f32 v36, v36, v12
    v_mul_f32 v37, v37, v12
    v_cvt_pk_bf16_f32 v18, v36, v37
    v_sub_f32 v38, v38, v8
    v_sub_f32 v39, v39, v8
    v_cvt_pk_bf16_f32 v9, v38, v39
    v_lshlrev_b32 v38, 16, v9
    v_and_b32 v39, 0xffff0000, v9
    v_mul_f32 v38, v38, v12
    v_mul_f32 v39, v39, v12
    v_cvt_pk_bf16_f32 v19, v38, v39
    v_sub_f32 v40, v40, v8
    v_sub_f32 v41, v41, v8
    v_cvt_pk_bf16_f32 v9, v40, v41
    v_lshlrev_b32 v40, 16, v9
    v_and_b32 v41, 0xffff0000, v9
    v_mul_f32 v40, v40, v12
    v_mul_f32 v41, v41, v12
    v_cvt_pk_bf16_f32 v20, v40, v41
    v_sub_f32 v42, v42, v8
    v_sub_f32 v43, v43, v8
    v_cvt_pk_bf16_f32 v9, v42, v43
    v_lshlrev_b32 v42, 16, v9
    v_and_b32 v43, 0xffff0000, v9
    v_mul_f32 v42, v42, v12
    v_mul_f32 v43, v43, v12
    v_cvt_pk_bf16_f32 v21, v42, v43
    v_sub_f32 v44, v44, v8
    v_sub_f32 v45, v45, v8
    v_cvt_pk_bf16_f32 v9, v44, v45
    v_lshlrev_b32 v44, 16, v9
    v_and_b32 v45, 0xffff0000, v9
    v_mul_f32 v44, v44, v12
    v_mul_f32 v45, v45, v12
    v_cvt_pk_bf16_f32 v22, v44, v45
    v_sub_f32 v46, v46, v8
    v_sub_f32 v47, v47, v8
    v_cvt_pk_bf16_f32 v9, v46, v47
    v_lshlrev_b32 v46, 16, v9
    v_and_b32 v47, 0xffff0000, v9
    v_mul_f32 v46, v46, v12
    v_mul_f32 v47, v47, v12
    v_cvt_pk_bf16_f32 v23, v46, v47
    v_cmp_eq_u32 vcc, s80, v1
    v_and_b32 v9, 15, v0
    v_lshlrev_b32 v9, 5, v9
    s_lshl_b32 s83, s76, 9
    v_add_u32 v9, s83, v9
    s_mov_b64 exec, vcc
    ds_write_b128 v9, v[16:19] offset:49152
    ds_write_b128 v9, v[20:23] offset:49168
    s_mov_b64 exec, -1
    v_lshlrev_b32 v8, 9, v2
    v_lshl_add_u32 v8, v11, 1, v8
    s_lshl_b32 s83, s100, 7
    v_add_u32 v8, s83, v8
    s_waitcnt lgkmcnt(0)
    s_barrier
    ds_read_b128 v[16:19], v8 offset:49152
    s_waitcnt vmcnt(4)
    s_add_u32 s77, s16, 49152
    buffer_load_dwordx4 v[88:91], v6, s[48:51], s77 offen offset:0 nt
    s_add_u32 s77, s16, 57344
    buffer_load_dwordx4 v[92:95], v6, s[48:51], s77 offen offset:0 nt
    s_waitcnt vmcnt(4)
    buffer_load_dwordx4 v[96:99], v7, s[52:55], s17 offen offset:0 nt
    s_add_u32 s77, s17, 4096
    buffer_load_dwordx4 v[100:103], v7, s[52:55], s77 offen offset:3072 nt
    s_waitcnt vmcnt(4)
    s_add_u32 s77, s17, 12288
    buffer_load_dwordx4 v[104:107], v7, s[52:55], s77 offen offset:2048 nt
    s_add_u32 s77, s17, 20480
    buffer_load_dwordx4 v[108:111], v7, s[52:55], s77 offen offset:1024 nt
    s_waitcnt vmcnt(4)
    s_add_u32 s77, s17, 28672
    buffer_load_dwordx4 v[112:115], v7, s[52:55], s77 offen offset:0 nt
    s_add_u32 s77, s17, 32768
    buffer_load_dwordx4 v[116:119], v7, s[52:55], s77 offen offset:3072 nt
    s_waitcnt vmcnt(6) lgkmcnt(0)
    v_perm_b32 v8, v68, v64, s78
    v_perm_b32 v9, v76, v72, s78
    v_perm_b32 v10, v84, v80, s78
    v_perm_b32 v11, v92, v88, s78
    v_perm_b32 v12, v68, v64, s79
    v_perm_b32 v13, v76, v72, s79
    v_perm_b32 v14, v84, v80, s79
    v_perm_b32 v15, v92, v88, s79
    v_mfma_f32_16x16x32_bf16 v[32:35], v[8:11], v[16:19], 0
    v_perm_b32 v8, v69, v65, s78
    v_perm_b32 v9, v77, v73, s78
    v_perm_b32 v10, v85, v81, s78
    v_perm_b32 v11, v93, v89, s78
    v_mfma_f32_16x16x32_bf16 v[36:39], v[12:15], v[16:19], 0
    v_perm_b32 v12, v69, v65, s79
    v_perm_b32 v13, v77, v73, s79
    v_perm_b32 v14, v85, v81, s79
    v_perm_b32 v15, v93, v89, s79
    v_mfma_f32_16x16x32_bf16 v[40:43], v[8:11], v[16:19], 0
    v_perm_b32 v8, v70, v66, s78
    v_perm_b32 v9, v78, v74, s78
    v_perm_b32 v10, v86, v82, s78
    v_perm_b32 v11, v94, v90, s78
    v_mfma_f32_16x16x32_bf16 v[44:47], v[12:15], v[16:19], 0
    v_perm_b32 v12, v70, v66, s79
    v_perm_b32 v13, v78, v74, s79
    v_perm_b32 v14, v86, v82, s79
    v_perm_b32 v15, v94, v90, s79
    v_mfma_f32_16x16x32_bf16 v[48:51], v[8:11], v[16:19], 0
    v_perm_b32 v8, v71, v67, s78
    v_perm_b32 v9, v79, v75, s78
    v_perm_b32 v10, v87, v83, s78
    v_perm_b32 v11, v95, v91, s78
    v_mfma_f32_16x16x32_bf16 v[52:55], v[12:15], v[16:19], 0
    v_perm_b32 v12, v71, v67, s79
    v_perm_b32 v13, v79, v75, s79
    v_perm_b32 v14, v87, v83, s79
    v_perm_b32 v15, v95, v91, s79
    v_mfma_f32_16x16x32_bf16 v[56:59], v[8:11], v[16:19], 0
    s_nop 1
    v_mfma_f32_16x16x32_bf16 v[60:63], v[12:15], v[16:19], 0
    s_lshl_b32 s83, s100, 12
    s_add_u32 s83, s83, 0
    v_lshlrev_b32 v8, 7, v1
    v_lshl_add_u32 v8, v2, 4, v8
    v_add_u32 v8, s83, v8
    s_mov_b64 exec, s[96:97]
    s_nop 5
    ds_write_b128 v8, v[32:35] offset:0
    ds_write_b128 v8, v[36:39] offset:512
    ds_write_b128 v8, v[40:43] offset:1024
    ds_write_b128 v8, v[44:47] offset:1536
    ds_write_b128 v8, v[48:51] offset:2048
    ds_write_b128 v8, v[52:55] offset:2560
    ds_write_b128 v8, v[56:59] offset:3072
    ds_write_b128 v8, v[60:63] offset:3584
    s_mov_b64 exec, -1
    s_waitcnt vmcnt(4)
    s_add_u32 s77, s17, 40960
    buffer_load_dwordx4 v[120:123], v7, s[52:55], s77 offen offset:2048 nt
    s_add_u32 s77, s17, 49152
    buffer_load_dwordx4 v[124:127], v7, s[52:55], s77 offen offset:1024 nt
    s_waitcnt vmcnt(4)
    buffer_load_dwordx4 v[128:131], v4, s[40:43], s89 offen offset:0 nt
    buffer_load_dwordx4 v[132:135], v4, s[40:43], s89 offen offset:64 nt
    s_waitcnt vmcnt(4)
    buffer_load_dwordx4 v[136:139], v4, s[40:43], s89 offen offset:128 nt
    buffer_load_dwordx4 v[140:143], v4, s[40:43], s89 offen offset:192 nt
    s_waitcnt vmcnt(4)
    s_add_u32 s77, s89, 4096
    buffer_load_dwordx4 v[144:147], v4, s[40:43], s77 offen offset:0 nt
    s_add_u32 s77, s89, 4096
    buffer_load_dwordx4 v[148:151], v4, s[40:43], s77 offen offset:64 nt
    s_waitcnt vmcnt(6)
    v_perm_b32 v8, v100, v96, s78
    v_perm_b32 v9, v108, v104, s78
    v_perm_b32 v10, v116, v112, s78
    v_perm_b32 v11, v124, v120, s78
    v_perm_b32 v12, v100, v96, s79
    v_perm_b32 v13, v108, v104, s79
    v_perm_b32 v14, v116, v112, s79
    v_perm_b32 v15, v124, v120, s79
    v_mfma_f32_16x16x32_bf16 v[32:35], v[8:11], v[16:19], 0
    v_perm_b32 v8, v101, v97, s78
    v_perm_b32 v9, v109, v105, s78
    v_perm_b32 v10, v117, v113, s78
    v_perm_b32 v11, v125, v121, s78
    v_mfma_f32_16x16x32_bf16 v[36:39], v[12:15], v[16:19], 0
    v_perm_b32 v12, v101, v97, s79
    v_perm_b32 v13, v109, v105, s79
    v_perm_b32 v14, v117, v113, s79
    v_perm_b32 v15, v125, v121, s79
    v_mfma_f32_16x16x32_bf16 v[40:43], v[8:11], v[16:19], 0
    v_perm_b32 v8, v102, v98, s78
    v_perm_b32 v9, v110, v106, s78
    v_perm_b32 v10, v118, v114, s78
    v_perm_b32 v11, v126, v122, s78
    v_mfma_f32_16x16x32_bf16 v[44:47], v[12:15], v[16:19], 0
    v_perm_b32 v12, v102, v98, s79
    v_perm_b32 v13, v110, v106, s79
    v_perm_b32 v14, v118, v114, s79
    v_perm_b32 v15, v126, v122, s79
    v_mfma_f32_16x16x32_bf16 v[48:51], v[8:11], v[16:19], 0
    v_perm_b32 v8, v103, v99, s78
    v_perm_b32 v9, v111, v107, s78
    v_perm_b32 v10, v119, v115, s78
    v_perm_b32 v11, v127, v123, s78
    v_mfma_f32_16x16x32_bf16 v[52:55], v[12:15], v[16:19], 0
    v_perm_b32 v12, v103, v99, s79
    v_perm_b32 v13, v111, v107, s79
    v_perm_b32 v14, v119, v115, s79
    v_perm_b32 v15, v127, v123, s79
    v_mfma_f32_16x16x32_bf16 v[56:59], v[8:11], v[16:19], 0
    s_nop 1
    v_mfma_f32_16x16x32_bf16 v[60:63], v[12:15], v[16:19], 0
    s_lshl_b32 s83, s100, 12
    s_add_u32 s83, s83, 0
    v_lshlrev_b32 v8, 7, v1
    v_lshl_add_u32 v8, v2, 4, v8
    v_add_u32 v8, s83, v8
    s_mov_b64 exec, s[96:97]
    s_nop 5
    ds_write_b128 v8, v[32:35] offset:16384
    ds_write_b128 v8, v[36:39] offset:16896
    ds_write_b128 v8, v[40:43] offset:17408
    ds_write_b128 v8, v[44:47] offset:17920
    ds_write_b128 v8, v[48:51] offset:18432
    ds_write_b128 v8, v[52:55] offset:18944
    ds_write_b128 v8, v[56:59] offset:19456
    ds_write_b128 v8, v[60:63] offset:19968
    s_mov_b64 exec, -1
    s_lshl_b32 s83, s100, 6
    v_add_u32 v12, s83, v0
    v_lshlrev_b32 v6, 4, v12
    v_and_b32 v9, 15, v0
    v_lshlrev_b32 v7, 14, v1
    v_lshl_add_u32 v7, v9, 4, v7
    s_add_u32 s77, s89, 4096
    buffer_load_dwordx4 v[152:155], v4, s[40:43], s77 offen offset:128 nt
    s_add_u32 s77, s89, 4096
    buffer_load_dwordx4 v[156:159], v4, s[40:43], s77 offen offset:192 nt
    s_add_u32 s77, s89, 8192
    buffer_load_dwordx4 v[160:163], v4, s[40:43], s77 offen offset:0 nt
    s_add_u32 s77, s89, 8192
    buffer_load_dwordx4 v[164:167], v4, s[40:43], s77 offen offset:64 nt
    s_waitcnt lgkmcnt(0)
    s_barrier
    v_mov_b32 v8, 59904
    ds_read_b64 v[28:29], v8
    s_waitcnt lgkmcnt(0)
    v_readfirstlane_b32 s82, v28
    v_readfirstlane_b32 s83, v29
    s_nop 3
    s_and_b32 s92, s82, 1023
    s_bfe_u32 s93, s82, 0xa000a
    s_bfe_u32 s94, s82, 0xa0014
    s_lshr_b32 s95, s82, 30
    s_and_b32 s83, s83, 0xff
    s_lshl_b32 s83, s83, 2
    s_or_b32 s95, s95, s83
    s_cmp_lt_u32 s76, 0
    s_cbranch_scc1 Lsk_1
    s_cmp_ge_u32 s76, 2
    s_cbranch_scc1 Lsk_1
    s_lshr_b32 s82, s76, 1
    s_and_b32 s83, s76, 1
    s_lshl_b32 s84, s82, 14
    s_lshl_b32 s85, s83, 9
    s_add_u32 s84, s84, s85
    v_lshlrev_b32 v8, 10, v1
    v_lshl_add_u32 v8, v3, 7, v8
    v_lshl_add_u32 v8, v2, 4, v8
    v_add_u32 v8, s84, v8
    ds_read_b128 v[32:35], v8 offset:0
    ds_read_b128 v[36:39], v8 offset:256
    ds_read_b128 v[40:43], v8 offset:4096
    ds_read_b128 v[44:47], v8 offset:4352
    ds_read_b128 v[48:51], v8 offset:8192
    ds_read_b128 v[52:55], v8 offset:8448
    ds_read_b128 v[56:59], v8 offset:12288
    ds_read_b128 v[60:63], v8 offset:12544
    s_cmp_eq_u32 s82, 1
    s_cselect_b32 s86, 2, 0
    s_cmp_eq_u32 s82, 2
    s_cselect_b32 s86, 5, s86
    s_add_u32 s86, s86, s81
    s_and_b32 s86, s86, 7
    s_and_b32 s87, s81, 0xf8
    s_or_b32 s86, s86, s87
    s_lshl_b32 s84, s82, 19
    s_lshl_b32 s85, s80, 17
    s_add_u32 s84, s84, s85
    s_lshl_b32 s85, s86, 8
    s_add_u32 s84, s84, s85
    s_lshl_b32 s85, s83, 4
    s_add_u32 s84, s84, s85
    v_lshlrev_b32 v9, 14, v2
    v_lshl_add_u32 v9, v3, 7, v9
    v_lshl_add_u32 v9, v1, 5, v9
    s_waitcnt lgkmcnt(0)
    v_add_f32 v24, v32, v36
    v_add_f32 v24, v24, v40
    v_add_f32 v24, v24, v44
    v_add_f32 v24, v24, v48
    v_add_f32 v24, v24, v52
    v_add_f32 v24, v24, v56
    v_add_f32 v24, v24, v60
    v_add_f32 v25, v33, v37
    v_add_f32 v25, v25, v41
    v_add_f32 v25, v25, v45
    v_add_f32 v25, v25, v49
    v_add_f32 v25, v25, v53
    v_add_f32 v25, v25, v57
    v_add_f32 v25, v25, v61
    v_add_f32 v26, v34, v38
    v_add_f32 v26, v26, v42
    v_add_f32 v26, v26, v46
    v_add_f32 v26, v26, v50
    v_add_f32 v26, v26, v54
    v_add_f32 v26, v26, v58
    v_add_f32 v26, v26, v62
    v_add_f32 v27, v35, v39
    v_add_f32 v27, v27, v43
    v_add_f32 v27, v27, v47
    v_add_f32 v27, v27, v51
    v_add_f32 v27, v27, v55
    v_add_f32 v27, v27, v59
    v_add_f32 v27, v27, v63
    v_mov_b32 v15, 0xff
    v_bfi_b32 v24, v15, s92, v24
    v_bfi_b32 v25, v15, s93, v25
    v_bfi_b32 v26, v15, s94, v26
    v_bfi_b32 v27, v15, s95, v27
    buffer_store_dwordx4 v[24:27], v9, s[64:67], s84 offen sc1
Lsk_1:
    s_cmp_ge_u32 s2, 224
    s_cbranch_scc1 Lsk_2
    s_cmp_lt_u32 s76, 2
    s_cbranch_scc1 Lsk_2
    s_cmp_ge_u32 s76, 4
    s_cbranch_scc1 Lsk_2
    s_lshr_b32 s82, s76, 1
    s_and_b32 s83, s76, 1
    s_lshl_b32 s84, s82, 14
    s_lshl_b32 s85, s83, 9
    s_add_u32 s84, s84, s85
    v_lshlrev_b32 v8, 10, v1
    v_lshl_add_u32 v8, v3, 7, v8
    v_lshl_add_u32 v8, v2, 4, v8
    v_add_u32 v8, s84, v8
    ds_read_b128 v[32:35], v8 offset:0
    ds_read_b128 v[36:39], v8 offset:256
    ds_read_b128 v[40:43], v8 offset:4096
    ds_read_b128 v[44:47], v8 offset:4352
    ds_read_b128 v[48:51], v8 offset:8192
    ds_read_b128 v[52:55], v8 offset:8448
    ds_read_b128 v[56:59], v8 offset:12288
    ds_read_b128 v[60:63], v8 offset:12544
    s_cmp_eq_u32 s82, 1
    s_cselect_b32 s86, 2, 0
    s_cmp_eq_u32 s82, 2
    s_cselect_b32 s86, 5, s86
    s_add_u32 s86, s86, s81
    s_and_b32 s86, s86, 7
    s_and_b32 s87, s81, 0xf8
    s_or_b32 s86, s86, s87
    s_lshl_b32 s84, s82, 19
    s_lshl_b32 s85, s80, 17
    s_add_u32 s84, s84, s85
    s_lshl_b32 s85, s86, 8
    s_add_u32 s84, s84, s85
    s_lshl_b32 s85, s83, 4
    s_add_u32 s84, s84, s85
    v_lshlrev_b32 v9, 14, v2
    v_lshl_add_u32 v9, v3, 7, v9
    v_lshl_add_u32 v9, v1, 5, v9
    s_waitcnt lgkmcnt(0)
    v_add_f32 v24, v32, v36
    v_add_f32 v24, v24, v40
    v_add_f32 v24, v24, v44
    v_add_f32 v24, v24, v48
    v_add_f32 v24, v24, v52
    v_add_f32 v24, v24, v56
    v_add_f32 v24, v24, v60
    v_add_f32 v25, v33, v37
    v_add_f32 v25, v25, v41
    v_add_f32 v25, v25, v45
    v_add_f32 v25, v25, v49
    v_add_f32 v25, v25, v53
    v_add_f32 v25, v25, v57
    v_add_f32 v25, v25, v61
    v_add_f32 v26, v34, v38
    v_add_f32 v26, v26, v42
    v_add_f32 v26, v26, v46
    v_add_f32 v26, v26, v50
    v_add_f32 v26, v26, v54
    v_add_f32 v26, v26, v58
    v_add_f32 v26, v26, v62
    v_add_f32 v27, v35, v39
    v_add_f32 v27, v27, v43
    v_add_f32 v27, v27, v47
    v_add_f32 v27, v27, v51
    v_add_f32 v27, v27, v55
    v_add_f32 v27, v27, v59
    v_add_f32 v27, v27, v63
    v_mov_b32 v15, 0xff
    v_bfi_b32 v24, v15, s92, v24
    v_bfi_b32 v25, v15, s93, v25
    v_bfi_b32 v26, v15, s94, v26
    v_bfi_b32 v27, v15, s95, v27
    buffer_store_dwordx4 v[24:27], v9, s[64:67], s84 offen sc1
Lsk_2:
    s_mov_b32 s88, 0
    s_waitcnt vmcnt(4)
    s_add_u32 s77, s89, 8192
    buffer_load_dwordx4 v[168:171], v4, s[40:43], s77 offen offset:128 nt
    s_add_u32 s77, s89, 8192
    buffer_load_dwordx4 v[172:175], v4, s[40:43], s77 offen offset:192 nt
    s_waitcnt vmcnt(4)
    s_add_u32 s77, s89, 12288
    buffer_load_dwordx4 v[176:179], v4, s[40:43], s77 offen offset:0 nt
    s_add_u32 s77, s89, 12288
    buffer_load_dwordx4 v[180:183], v4, s[40:43], s77 offen offset:64 nt
    s_waitcnt vmcnt(4)
    s_add_u32 s77, s89, 12288
    buffer_load_dwordx4 v[184:187], v4, s[40:43], s77 offen offset:128 nt
    s_add_u32 s77, s89, 12288
    buffer_load_dwordx4 v[188:191], v4, s[40:43], s77 offen offset:192 nt
    s_waitcnt vmcnt(4)
    buffer_load_dwordx4 v[192:195], v5, s[44:47], s89 offen offset:0 nt
    buffer_load_dwordx4 v[196:199], v5, s[44:47], s89 offen offset:256 nt
    s_waitcnt vmcnt(4)
    buffer_load_dwordx4 v[200:203], v5, s[44:47], s89 offen offset:512 nt
    buffer_load_dwordx4 v[204:207], v5, s[44:47], s89 offen offset:768 nt
    s_waitcnt vmcnt(4)
    s_add_u32 s77, s89, 4096
    buffer_load_dwordx4 v[208:211], v5, s[44:47], s77 offen offset:0 nt
    s_add_u32 s77, s89, 4096
    buffer_load_dwordx4 v[212:215], v5, s[44:47], s77 offen offset:256 nt
    s_waitcnt vmcnt(4)
    s_add_u32 s77, s89, 4096
    buffer_load_dwordx4 v[216:219], v5, s[44:47], s77 offen offset:512 nt
    s_add_u32 s77, s89, 4096
    buffer_load_dwordx4 v[220:223], v5, s[44:47], s77 offen offset:768 nt
    s_waitcnt vmcnt(4)
    s_add_u32 s77, s18, 0
    buffer_load_dwordx4 v[64:67], v6, s[64:67], s77 offen sc1
    s_add_u32 s77, s18, 131072
    buffer_load_dwordx4 v[68:71], v6, s[64:67], s77 offen sc1
    s_waitcnt vmcnt(4)
    s_add_u32 s77, s18, 262144
    buffer_load_dwordx4 v[72:75], v6, s[64:67], s77 offen sc1
    s_add_u32 s77, s18, 393216
    buffer_load_dwordx4 v[76:79], v6, s[64:67], s77 offen sc1
    s_waitcnt vmcnt(4)
    s_add_u32 s77, s89, 8192
    buffer_load_dwordx4 v[224:227], v5, s[44:47], s77 offen offset:0 nt
    s_add_u32 s77, s89, 8192
    buffer_load_dwordx4 v[228:231], v5, s[44:47], s77 offen offset:256 nt
    s_waitcnt vmcnt(4)
    s_add_u32 s77, s89, 8192
    buffer_load_dwordx4 v[232:235], v5, s[44:47], s77 offen offset:512 nt
    s_add_u32 s77, s89, 8192
    buffer_load_dwordx4 v[236:239], v5, s[44:47], s77 offen offset:768 nt
    s_waitcnt vmcnt(4)
    s_add_u32 s77, s89, 12288
    buffer_load_dwordx4 v[240:243], v5, s[44:47], s77 offen offset:0 nt
    s_add_u32 s77, s89, 12288
    buffer_load_dwordx4 v[244:247], v5, s[44:47], s77 offen offset:256 nt
    s_waitcnt vmcnt(6)
Lchk_3:
    v_mov_b32 v8, 0
    v_xor_b32 v9, s92, v64
    v_xor_b32 v10, s93, v65
    v_or3_b32 v8, v8, v9, v10
    v_xor_b32 v9, s94, v66
    v_xor_b32 v10, s95, v67
    v_or3_b32 v8, v8, v9, v10
    v_xor_b32 v9, s92, v68
    v_xor_b32 v10, s93, v69
    v_or3_b32 v8, v8, v9, v10
    v_xor_b32 v9, s94, v70
    v_xor_b32 v10, s95, v71
    v_or3_b32 v8, v8, v9, v10
    v_xor_b32 v9, s92, v72
    v_xor_b32 v10, s93, v73
    v_or3_b32 v8, v8, v9, v10
    v_xor_b32 v9, s94, v74
    v_xor_b32 v10, s95, v75
    v_or3_b32 v8, v8, v9, v10
    v_xor_b32 v9, s92, v76
    v_xor_b32 v10, s93, v77
    v_or3_b32 v8, v8, v9, v10
    v_xor_b32 v9, s94, v78
    v_xor_b32 v10, s95, v79
    v_or3_b32 v8, v8, v9, v10
    v_and_b32 v8, 255, v8
    v_cmp_ne_u32 vcc, 0, v8
    s_cbranch_vccz Lok_4
    s_add_u32 s88, s88, 1
    s_cmp_ge_u32 s88, 100000
    s_cbranch_scc1 Lok_4
    s_mov_b64 exec, vcc
    s_add_u32 s77, s18, 0
    buffer_load_dwordx4 v[64:67], v6, s[64:67], s77 offen sc1
    s_add_u32 s77, s18, 131072
    buffer_load_dwordx4 v[68:71], v6, s[64:67], s77 offen sc1
    s_add_u32 s77, s18, 262144
    buffer_load_dwordx4 v[72:75], v6, s[64:67], s77 offen sc1
    s_add_u32 s77, s18, 393216
    buffer_load_dwordx4 v[76:79], v6, s[64:67], s77 offen sc1
    s_waitcnt vmcnt(0)
    s_mov_b64 exec, -1
    s_branch Lchk_3
Lok_4:
    s_lshl_b32 s83, s100, 6
    v_add_u32 v12, s83, v0
    v_lshrrev_b32 v14, 4, v12
    v_lshlrev_b32 v14, 7, v14
    v_lshl_add_u32 v14, v3, 6, v14
    v_lshl_add_u32 v14, v2, 1, v14
    v_add_f32 v64, v64, v68
    v_add_f32 v72, v72, v76
    v_add_f32 v64, v64, v72
    v_add_f32 v65, v65, v69
    v_add_f32 v73, v73, v77
    v_add_f32 v65, v65, v73
    v_add_f32 v66, v66, v70
    v_add_f32 v74, v74, v78
    v_add_f32 v66, v66, v74
    v_add_f32 v67, v67, v71
    v_add_f32 v75, v75, v79
    v_add_f32 v67, v67, v75
    v_cvt_pk_bf16_f32 v8, v64, v65
    v_cvt_pk_bf16_f32 v9, v66, v67
    ds_write_b16 v14, v8 offset:53248
    ds_write_b16_d16_hi v14, v8 offset:53264
    ds_write_b16 v14, v9 offset:53280
    ds_write_b16_d16_hi v14, v9 offset:53296
    s_add_u32 s77, s89, 12288
    buffer_load_dwordx4 v[248:251], v5, s[44:47], s77 offen offset:512 nt
    s_add_u32 s77, s89, 12288
    buffer_load_dwordx4 v[252:255], v5, s[44:47], s77 offen offset:768 nt
    s_waitcnt lgkmcnt(0)
    s_barrier
    v_lshlrev_b32 v8, 8, v2
    v_lshl_add_u32 v8, v1, 4, v8
    ds_read_b128 v[16:19], v8 offset:53248
    ds_read_b128 v[20:23], v8 offset:53312
    ds_read_b128 v[24:27], v8 offset:53376
    ds_read_b128 v[28:31], v8 offset:53440
    s_waitcnt vmcnt(20) lgkmcnt(0)
    v_mfma_f32_16x16x32_bf16 v[32:35], v[128:131], v[16:19], 0
    v_mfma_f32_16x16x32_bf16 v[36:39], v[144:147], v[16:19], 0
    v_mfma_f32_16x16x32_bf16 v[32:35], v[132:135], v[20:23], v[32:35]
    v_mfma_f32_16x16x32_bf16 v[36:39], v[148:151], v[20:23], v[36:39]
    v_mfma_f32_16x16x32_bf16 v[32:35], v[136:139], v[24:27], v[32:35]
    v_mfma_f32_16x16x32_bf16 v[36:39], v[152:155], v[24:27], v[36:39]
    v_mfma_f32_16x16x32_bf16 v[32:35], v[140:143], v[28:31], v[32:35]
    v_mfma_f32_16x16x32_bf16 v[36:39], v[156:159], v[28:31], v[36:39]
    v_mfma_f32_16x16x32_bf16 v[40:43], v[160:163], v[16:19], 0
    v_mfma_f32_16x16x32_bf16 v[44:47], v[176:179], v[16:19], 0
    v_mfma_f32_16x16x32_bf16 v[40:43], v[164:167], v[20:23], v[40:43]
    v_mfma_f32_16x16x32_bf16 v[44:47], v[180:183], v[20:23], v[44:47]
    v_mfma_f32_16x16x32_bf16 v[40:43], v[168:171], v[24:27], v[40:43]
    v_mfma_f32_16x16x32_bf16 v[44:47], v[184:187], v[24:27], v[44:47]
    v_mfma_f32_16x16x32_bf16 v[40:43], v[172:175], v[28:31], v[40:43]
    v_mfma_f32_16x16x32_bf16 v[44:47], v[188:191], v[28:31], v[44:47]
    s_nop 7
    s_mov_b32 s82, 0x3db504f3
    v_cvt_pk_bf16_f32 v8, v32, v33
    v_lshlrev_b32 v32, 16, v8
    v_and_b32 v33, 0xffff0000, v8
    v_mul_f32 v32, s82, v32
    v_mul_f32 v33, s82, v33
    v_cvt_pk_bf16_f32 v8, v32, v33
    v_lshlrev_b32 v32, 16, v8
    v_and_b32 v33, 0xffff0000, v8
    v_cvt_pk_bf16_f32 v8, v34, v35
    v_lshlrev_b32 v34, 16, v8
    v_and_b32 v35, 0xffff0000, v8
    v_mul_f32 v34, s82, v34
    v_mul_f32 v35, s82, v35
    v_cvt_pk_bf16_f32 v8, v34, v35
    v_lshlrev_b32 v34, 16, v8
    v_and_b32 v35, 0xffff0000, v8
    v_cvt_pk_bf16_f32 v8, v36, v37
    v_lshlrev_b32 v36, 16, v8
    v_and_b32 v37, 0xffff0000, v8
    v_mul_f32 v36, s82, v36
    v_mul_f32 v37, s82, v37
    v_cvt_pk_bf16_f32 v8, v36, v37
    v_lshlrev_b32 v36, 16, v8
    v_and_b32 v37, 0xffff0000, v8
    v_cvt_pk_bf16_f32 v8, v38, v39
    v_lshlrev_b32 v38, 16, v8
    v_and_b32 v39, 0xffff0000, v8
    v_mul_f32 v38, s82, v38
    v_mul_f32 v39, s82, v39
    v_cvt_pk_bf16_f32 v8, v38, v39
    v_lshlrev_b32 v38, 16, v8
    v_and_b32 v39, 0xffff0000, v8
    v_cvt_pk_bf16_f32 v8, v40, v41
    v_lshlrev_b32 v40, 16, v8
    v_and_b32 v41, 0xffff0000, v8
    v_mul_f32 v40, s82, v40
    v_mul_f32 v41, s82, v41
    v_cvt_pk_bf16_f32 v8, v40, v41
    v_lshlrev_b32 v40, 16, v8
    v_and_b32 v41, 0xffff0000, v8
    v_cvt_pk_bf16_f32 v8, v42, v43
    v_lshlrev_b32 v42, 16, v8
    v_and_b32 v43, 0xffff0000, v8
    v_mul_f32 v42, s82, v42
    v_mul_f32 v43, s82, v43
    v_cvt_pk_bf16_f32 v8, v42, v43
    v_lshlrev_b32 v42, 16, v8
    v_and_b32 v43, 0xffff0000, v8
    v_cvt_pk_bf16_f32 v8, v44, v45
    v_lshlrev_b32 v44, 16, v8
    v_and_b32 v45, 0xffff0000, v8
    v_mul_f32 v44, s82, v44
    v_mul_f32 v45, s82, v45
    v_cvt_pk_bf16_f32 v8, v44, v45
    v_lshlrev_b32 v44, 16, v8
    v_and_b32 v45, 0xffff0000, v8
    v_cvt_pk_bf16_f32 v8, v46, v47
    v_lshlrev_b32 v46, 16, v8
    v_and_b32 v47, 0xffff0000, v8
    v_mul_f32 v46, s82, v46
    v_mul_f32 v47, s82, v47
    v_cvt_pk_bf16_f32 v8, v46, v47
    v_lshlrev_b32 v46, 16, v8
    v_and_b32 v47, 0xffff0000, v8
    s_mov_b32 s91, 0x3fb8aa3b
    v_max3_f32 v8, v32, v33, v34
    v_max3_f32 v8, v8, v35, v36
    v_max3_f32 v8, v8, v37, v38
    v_max3_f32 v8, v8, v39, v40
    v_max3_f32 v8, v8, v41, v42
    v_max3_f32 v8, v8, v43, v44
    v_max3_f32 v8, v8, v45, v46
    v_max_f32 v8, v8, v47
    v_mov_b32 v9, v8
    s_nop 1
    v_permlane16_swap_b32 v8, v9
    s_nop 1
    v_max_f32 v8, v8, v9
    v_mov_b32 v9, v8
    s_nop 1
    v_permlane32_swap_b32 v8, v9
    s_nop 1
    v_max_f32 v8, v8, v9
    v_mul_f32 v8, s91, v8
    v_fma_f32 v32, v32, s91, -v8
    v_fma_f32 v33, v33, s91, -v8
    v_fma_f32 v34, v34, s91, -v8
    v_fma_f32 v35, v35, s91, -v8
    v_fma_f32 v36, v36, s91, -v8
    v_fma_f32 v37, v37, s91, -v8
    v_fma_f32 v38, v38, s91, -v8
    v_fma_f32 v39, v39, s91, -v8
    v_fma_f32 v40, v40, s91, -v8
    v_fma_f32 v41, v41, s91, -v8
    v_fma_f32 v42, v42, s91, -v8
    v_fma_f32 v43, v43, s91, -v8
    v_fma_f32 v44, v44, s91, -v8
    v_fma_f32 v45, v45, s91, -v8
    v_fma_f32 v46, v46, s91, -v8
    v_fma_f32 v47, v47, s91, -v8
    v_exp_f32 v32, v32
    v_exp_f32 v33, v33
    v_exp_f32 v34, v34
    v_exp_f32 v35, v35
    v_exp_f32 v36, v36
    v_exp_f32 v37, v37
    v_exp_f32 v38, v38
    v_exp_f32 v39, v39
    v_exp_f32 v40, v40
    v_exp_f32 v41, v41
    v_exp_f32 v42, v42
    v_exp_f32 v43, v43
    v_exp_f32 v44, v44
    v_exp_f32 v45, v45
    v_exp_f32 v46, v46
    v_exp_f32 v47, v47
    s_nop 0
    v_cvt_pk_bf16_f32 v16, v32, v33
    v_cvt_pk_bf16_f32 v17, v34, v35
    v_cvt_pk_bf16_f32 v18, v36, v37
    v_cvt_pk_bf16_f32 v19, v38, v39
    v_cvt_pk_bf16_f32 v20, v40, v41
    v_cvt_pk_bf16_f32 v21, v42, v43
    v_cvt_pk_bf16_f32 v22, v44, v45
    v_cvt_pk_bf16_f32 v23, v46, v47
    v_mov_b32 v9, 0
    v_lshlrev_b32 v10, 16, v16
    v_and_b32 v11, 0xffff0000, v16
    v_add_f32 v9, v9, v10
    v_add_f32 v9, v9, v11
    v_lshlrev_b32 v10, 16, v17
    v_and_b32 v11, 0xffff0000, v17
    v_add_f32 v9, v9, v10
    v_add_f32 v9, v9, v11
    v_lshlrev_b32 v10, 16, v18
    v_and_b32 v11, 0xffff0000, v18
    v_add_f32 v9, v9, v10
    v_add_f32 v9, v9, v11
    v_lshlrev_b32 v10, 16, v19
    v_and_b32 v11, 0xffff0000, v19
    v_add_f32 v9, v9, v10
    v_add_f32 v9, v9, v11
    v_lshlrev_b32 v10, 16, v20
    v_and_b32 v11, 0xffff0000, v20
    v_add_f32 v9, v9, v10
    v_add_f32 v9, v9, v11
    v_lshlrev_b32 v10, 16, v21
    v_and_b32 v11, 0xffff0000, v21
    v_add_f32 v9, v9, v10
    v_add_f32 v9, v9, v11
    v_lshlrev_b32 v10, 16, v22
    v_and_b32 v11, 0xffff0000, v22
    v_add_f32 v9, v9, v10
    v_add_f32 v9, v9, v11
    v_lshlrev_b32 v10, 16, v23
    v_and_b32 v11, 0xffff0000, v23
    v_add_f32 v9, v9, v10
    v_add_f32 v9, v9, v11
    v_mov_b32 v10, v9
    s_nop 1
    v_permlane16_swap_b32 v9, v10
    s_nop 1
    v_add_f32 v9, v9, v10
    v_mov_b32 v10, v9
    s_nop 1
    v_permlane32_swap_b32 v9, v10
    s_nop 1
    v_add_f32 v9, v9, v10
    v_lshlrev_b32 v10, 3, v0
    s_lshl_b32 s83, s76, 6
    v_add_u32 v10, s83, v10
    s_mov_b64 exec, 0xff
    ds_write_b64 v10, v[8:9] offset:59392
    s_mov_b64 exec, -1
    s_nop 1
    s_waitcnt vmcnt(12)
    v_perm_b32 v8, v196, v192, s78
    v_perm_b32 v9, v204, v200, s78
    v_perm_b32 v10, v212, v208, s78
    v_perm_b32 v11, v220, v216, s78
    v_perm_b32 v12, v196, v192, s79
    v_perm_b32 v13, v204, v200, s79
    v_perm_b32 v14, v212, v208, s79
    v_perm_b32 v15, v220, v216, s79
    v_mfma_f32_16x16x32_bf16 v[32:35], v[8:11], v[16:19], 0
    v_perm_b32 v8, v197, v193, s78
    v_perm_b32 v9, v205, v201, s78
    v_perm_b32 v10, v213, v209, s78
    v_perm_b32 v11, v221, v217, s78
    v_mfma_f32_16x16x32_bf16 v[36:39], v[12:15], v[16:19], 0
    v_perm_b32 v12, v197, v193, s79
    v_perm_b32 v13, v205, v201, s79
    v_perm_b32 v14, v213, v209, s79
    v_perm_b32 v15, v221, v217, s79
    v_mfma_f32_16x16x32_bf16 v[40:43], v[8:11], v[16:19], 0
    v_perm_b32 v8, v198, v194, s78
    v_perm_b32 v9, v206, v202, s78
    v_perm_b32 v10, v214, v210, s78
    v_perm_b32 v11, v222, v218, s78
    v_mfma_f32_16x16x32_bf16 v[44:47], v[12:15], v[16:19], 0
    v_perm_b32 v12, v198, v194, s79
    v_perm_b32 v13, v206, v202, s79
    v_perm_b32 v14, v214, v210, s79
    v_perm_b32 v15, v222, v218, s79
    v_mfma_f32_16x16x32_bf16 v[48:51], v[8:11], v[16:19], 0
    v_perm_b32 v8, v199, v195, s78
    v_perm_b32 v9, v207, v203, s78
    v_perm_b32 v10, v215, v211, s78
    v_perm_b32 v11, v223, v219, s78
    v_mfma_f32_16x16x32_bf16 v[52:55], v[12:15], v[16:19], 0
    v_perm_b32 v12, v199, v195, s79
    v_perm_b32 v13, v207, v203, s79
    v_perm_b32 v14, v215, v211, s79
    v_perm_b32 v15, v223, v219, s79
    v_mfma_f32_16x16x32_bf16 v[56:59], v[8:11], v[16:19], 0
    s_nop 1
    v_mfma_f32_16x16x32_bf16 v[60:63], v[12:15], v[16:19], 0
    s_waitcnt vmcnt(0)
    v_perm_b32 v8, v228, v224, s78
    v_perm_b32 v9, v236, v232, s78
    v_perm_b32 v10, v244, v240, s78
    v_perm_b32 v11, v252, v248, s78
    v_perm_b32 v12, v228, v224, s79
    v_perm_b32 v13, v236, v232, s79
    v_perm_b32 v14, v244, v240, s79
    v_perm_b32 v15, v252, v248, s79
    v_mfma_f32_16x16x32_bf16 v[32:35], v[8:11], v[20:23], v[32:35]
    v_perm_b32 v8, v229, v225, s78
    v_perm_b32 v9, v237, v233, s78
    v_perm_b32 v10, v245, v241, s78
    v_perm_b32 v11, v253, v249, s78
    v_mfma_f32_16x16x32_bf16 v[36:39], v[12:15], v[20:23], v[36:39]
    v_perm_b32 v12, v229, v225, s79
    v_perm_b32 v13, v237, v233, s79
    v_perm_b32 v14, v245, v241, s79
    v_perm_b32 v15, v253, v249, s79
    v_mfma_f32_16x16x32_bf16 v[40:43], v[8:11], v[20:23], v[40:43]
    v_perm_b32 v8, v230, v226, s78
    v_perm_b32 v9, v238, v234, s78
    v_perm_b32 v10, v246, v242, s78
    v_perm_b32 v11, v254, v250, s78
    v_mfma_f32_16x16x32_bf16 v[44:47], v[12:15], v[20:23], v[44:47]
    v_perm_b32 v12, v230, v226, s79
    v_perm_b32 v13, v238, v234, s79
    v_perm_b32 v14, v246, v242, s79
    v_perm_b32 v15, v254, v250, s79
    v_mfma_f32_16x16x32_bf16 v[48:51], v[8:11], v[20:23], v[48:51]
    v_perm_b32 v8, v231, v227, s78
    v_perm_b32 v9, v239, v235, s78
    v_perm_b32 v10, v247, v243, s78
    v_perm_b32 v11, v255, v251, s78
    v_mfma_f32_16x16x32_bf16 v[52:55], v[12:15], v[20:23], v[52:55]
    v_perm_b32 v12, v231, v227, s79
    v_perm_b32 v13, v239, v235, s79
    v_perm_b32 v14, v247, v243, s79
    v_perm_b32 v15, v255, v251, s79
    v_mfma_f32_16x16x32_bf16 v[56:59], v[8:11], v[20:23], v[56:59]
    s_nop 1
    v_mfma_f32_16x16x32_bf16 v[60:63], v[12:15], v[20:23], v[60:63]
    s_lshl_b32 s83, s76, 12
    s_add_u32 s83, s83, 61440
    v_lshlrev_b32 v8, 7, v1
    v_lshl_add_u32 v8, v2, 4, v8
    v_add_u32 v8, s83, v8
    s_mov_b64 exec, s[98:99]
    s_nop 5
    ds_write_b128 v8, v[32:35] offset:0
    ds_write_b128 v8, v[36:39] offset:512
    ds_write_b128 v8, v[40:43] offset:1024
    ds_write_b128 v8, v[44:47] offset:1536
    ds_write_b128 v8, v[48:51] offset:2048
    ds_write_b128 v8, v[52:55] offset:2560
    ds_write_b128 v8, v[56:59] offset:3072
    ds_write_b128 v8, v[60:63] offset:3584
    s_mov_b64 exec, -1
    s_waitcnt lgkmcnt(0)
    s_barrier
    s_lshl_b32 s83, s76, 3
    v_mov_b32 v8, s83
    ds_read_b64 v[16:17], v8 offset:59392
    ds_read_b64 v[18:19], v8 offset:59456
    ds_read_b64 v[20:21], v8 offset:59520
    ds_read_b64 v[22:23], v8 offset:59584
    ds_read_b64 v[24:25], v8 offset:59648
    ds_read_b64 v[26:27], v8 offset:59712
    ds_read_b64 v[28:29], v8 offset:59776
    ds_read_b64 v[30:31], v8 offset:59840
    v_lshrrev_b32 v9, 5, v0
    v_bfe_u32 v10, v0, 3, 2
    v_lshlrev_b32 v11, 14, v9
    v_lshl_add_u32 v11, v2, 9, v11
    v_lshl_add_u32 v11, v10, 7, v11
    s_lshl_b32 s83, s76, 4
    s_add_u32 s83, s83, 61440
    v_add_u32 v11, s83, v11
    ds_read_b128 v[32:35], v11 offset:0
    ds_read_b128 v[36:39], v11 offset:4096
    ds_read_b128 v[40:43], v11 offset:8192
    ds_read_b128 v[44:47], v11 offset:12288
    v_mov_b32 v15, 0x3ff
    s_waitcnt lgkmcnt(4)
    v_max3_f32 v48, v16, v18, v20
    v_max3_f32 v48, v48, v22, v24
    v_max3_f32 v48, v48, v26, v28
    v_max_f32 v48, v48, v30
    v_bfi_b32 v48, v15, s92, v48
    v_sub_f32 v52, v16, v48
    v_exp_f32 v52, v52
    v_sub_f32 v53, v18, v48
    v_exp_f32 v53, v53
    v_sub_f32 v54, v20, v48
    v_exp_f32 v54, v54
    v_sub_f32 v55, v22, v48
    v_exp_f32 v55, v55
    v_sub_f32 v56, v24, v48
    v_exp_f32 v56, v56
    v_sub_f32 v57, v26, v48
    v_exp_f32 v57, v57
    v_sub_f32 v58, v28, v48
    v_exp_f32 v58, v58
    v_sub_f32 v59, v30, v48
    v_exp_f32 v59, v59
    s_nop 0
    v_mul_f32 v49, v52, v17
    v_fmac_f32 v49, v53, v19
    v_fmac_f32 v49, v54, v21
    v_fmac_f32 v49, v55, v23
    v_fmac_f32 v49, v56, v25
    v_fmac_f32 v49, v57, v27
    v_fmac_f32 v49, v58, v29
    v_fmac_f32 v49, v59, v31
    v_cmp_lt_u32 vcc, 31, v0
    s_nop 1
    v_cndmask_b32 v52, v52, v56, vcc
    v_cndmask_b32 v53, v53, v57, vcc
    v_cndmask_b32 v54, v54, v58, vcc
    v_cndmask_b32 v55, v55, v59, vcc
    s_waitcnt lgkmcnt(0)
    v_mul_f32 v24, v52, v32
    v_fmac_f32 v24, v53, v36
    v_fmac_f32 v24, v54, v40
    v_fmac_f32 v24, v55, v44
    v_mul_f32 v25, v52, v33
    v_fmac_f32 v25, v53, v37
    v_fmac_f32 v25, v54, v41
    v_fmac_f32 v25, v55, v45
    v_mul_f32 v26, v52, v34
    v_fmac_f32 v26, v53, v38
    v_fmac_f32 v26, v54, v42
    v_fmac_f32 v26, v55, v46
    v_mul_f32 v27, v52, v35
    v_fmac_f32 v27, v53, v39
    v_fmac_f32 v27, v54, v43
    v_fmac_f32 v27, v55, v47
    v_mov_b32 v28, v24
    v_mov_b32 v29, v25
    v_mov_b32 v30, v26
    v_mov_b32 v31, v27
    s_nop 1
    v_permlane32_swap_b32 v24, v28
    v_permlane32_swap_b32 v25, v29
    v_permlane32_swap_b32 v26, v30
    v_permlane32_swap_b32 v27, v31
    s_nop 1
    v_add_f32 v24, v24, v28
    v_add_f32 v25, v25, v29
    v_add_f32 v26, v26, v30
    v_add_f32 v27, v27, v31
    v_cndmask_b32 v24, v24, v48, vcc
    v_cndmask_b32 v25, v25, v49, vcc
    v_cndmask_b32 v26, v26, v48, vcc
    v_cndmask_b32 v27, v27, v49, vcc
    v_lshlrev_b32 v9, 4, v0
    v_min_u32 v9, 512, v9
    v_mov_b32 v15, 0x3ff
    v_bfi_b32 v24, v15, s92, v24
    v_bfi_b32 v25, v15, s93, v25
    v_bfi_b32 v26, v15, s94, v26
    v_bfi_b32 v27, v15, s95, v27
    s_lshr_b32 s82, s2, 3
    s_lshl_b32 s82, s82, 3
    s_add_u32 s82, s82, s76
    s_lshl_b32 s82, s82, 3
    s_and_b32 s83, s2, 7
    s_add_u32 s82, s82, s83
    s_mul_i32 s82, s82, 576
    s_add_u32 s82, s82, 2097152
    s_mov_b32 exec_hi, 1
    buffer_store_dwordx4 v[24:27], v9, s[64:67], s82 offen sc1
    s_mov_b64 exec, -1
    buffer_load_dwordx4 v[64:67], v7, s[56:59], s90 offen offset:0 nt
    buffer_load_dwordx4 v[68:71], v7, s[56:59], s90 offen offset:2048 nt
    s_add_u32 s77, s90, 4096
    buffer_load_dwordx4 v[72:75], v7, s[56:59], s77 offen offset:0 nt
    s_add_u32 s77, s90, 4096
    buffer_load_dwordx4 v[76:79], v7, s[56:59], s77 offen offset:2048 nt
    s_add_u32 s77, s90, 8192
    buffer_load_dwordx4 v[80:83], v7, s[56:59], s77 offen offset:0 nt
    s_add_u32 s77, s90, 8192
    buffer_load_dwordx4 v[84:87], v7, s[56:59], s77 offen offset:2048 nt
    s_add_u32 s77, s90, 12288
    buffer_load_dwordx4 v[88:91], v7, s[56:59], s77 offen offset:0 nt
    s_add_u32 s77, s90, 12288
    buffer_load_dwordx4 v[92:95], v7, s[56:59], s77 offen offset:2048 nt
    v_lshlrev_b32 v6, 8, v2
    v_lshl_add_u32 v6, v1, 4, v6
    s_lshl_b32 s83, s100, 6
    v_add_u32 v6, s83, v6
    ds_read_b128 v[16:19], v6 offset:55296
    s_waitcnt vmcnt(0) lgkmcnt(0)
    v_perm_b32 v8, v68, v64, s78
    v_perm_b32 v9, v76, v72, s78
    v_perm_b32 v10, v84, v80, s78
    v_perm_b32 v11, v92, v88, s78
    v_perm_b32 v12, v68, v64, s79
    v_perm_b32 v13, v76, v72, s79
    v_perm_b32 v14, v84, v80, s79
    v_perm_b32 v15, v92, v88, s79
    v_mfma_f32_16x16x32_bf16 v[32:35], v[8:11], v[16:19], 0
    v_perm_b32 v8, v69, v65, s78
    v_perm_b32 v9, v77, v73, s78
    v_perm_b32 v10, v85, v81, s78
    v_perm_b32 v11, v93, v89, s78
    v_mfma_f32_16x16x32_bf16 v[36:39], v[12:15], v[16:19], 0
    v_perm_b32 v12, v69, v65, s79
    v_perm_b32 v13, v77, v73, s79
    v_perm_b32 v14, v85, v81, s79
    v_perm_b32 v15, v93, v89, s79
    v_mfma_f32_16x16x32_bf16 v[40:43], v[8:11], v[16:19], 0
    v_perm_b32 v8, v70, v66, s78
    v_perm_b32 v9, v78, v74, s78
    v_perm_b32 v10, v86, v82, s78
    v_perm_b32 v11, v94, v90, s78
    v_mfma_f32_16x16x32_bf16 v[44:47], v[12:15], v[16:19], 0
    v_perm_b32 v12, v70, v66, s79
    v_perm_b32 v13, v78, v74, s79
    v_perm_b32 v14, v86, v82, s79
    v_perm_b32 v15, v94, v90, s79
    v_mfma_f32_16x16x32_bf16 v[48:51], v[8:11], v[16:19], 0
    v_perm_b32 v8, v71, v67, s78
    v_perm_b32 v9, v79, v75, s78
    v_perm_b32 v10, v87, v83, s78
    v_perm_b32 v11, v95, v91, s78
    v_mfma_f32_16x16x32_bf16 v[52:55], v[12:15], v[16:19], 0
    v_perm_b32 v12, v71, v67, s79
    v_perm_b32 v13, v79, v75, s79
    v_perm_b32 v14, v87, v83, s79
    v_perm_b32 v15, v95, v91, s79
    v_mfma_f32_16x16x32_bf16 v[56:59], v[8:11], v[16:19], 0
    s_nop 1
    v_mfma_f32_16x16x32_bf16 v[60:63], v[12:15], v[16:19], 0
    s_lshl_b32 s83, s100, 12
    s_add_u32 s83, s83, 0
    v_lshlrev_b32 v8, 7, v1
    v_lshl_add_u32 v8, v2, 4, v8
    v_add_u32 v8, s83, v8
    s_mov_b64 exec, s[98:99]
    s_nop 5
    ds_write_b128 v8, v[32:35] offset:32768
    ds_write_b128 v8, v[36:39] offset:33280
    ds_write_b128 v8, v[40:43] offset:33792
    ds_write_b128 v8, v[44:47] offset:34304
    ds_write_b128 v8, v[48:51] offset:34816
    ds_write_b128 v8, v[52:55] offset:35328
    ds_write_b128 v8, v[56:59] offset:35840
    ds_write_b128 v8, v[60:63] offset:36352
    s_mov_b64 exec, -1
    s_waitcnt lgkmcnt(0)
    s_barrier
    s_cmp_ge_u32 s2, 224
    s_cbranch_scc1 Lsd_5
    v_lshrrev_b32 v9, 3, v0
    v_lshlrev_b32 v10, 9, v9
    v_lshl_add_u32 v10, v2, 4, v10
    s_lshl_b32 s83, s100, 7
    v_add_u32 v10, s83, v10
    ds_read_b128 v[32:35], v10 offset:32768
    ds_read_b128 v[36:39], v10 offset:36864
    ds_read_b128 v[40:43], v10 offset:40960
    ds_read_b128 v[44:47], v10 offset:45056
    v_lshlrev_b32 v11, 12, v2
    v_lshl_add_u32 v11, v9, 4, v11
    s_lshr_b32 s86, s2, 3
    s_lshl_b32 s86, s86, 15
    s_and_b32 s87, s2, 7
    s_lshl_b32 s87, s87, 9
    s_add_u32 s86, s86, s87
    s_add_u32 s86, s86, s83
    s_add_u32 s86, s86, 5242880
    s_waitcnt lgkmcnt(0)
    v_add_f32 v24, v32, v36
    v_add_f32 v28, v40, v44
    v_add_f32 v24, v24, v28
    v_add_f32 v25, v33, v37
    v_add_f32 v29, v41, v45
    v_add_f32 v25, v25, v29
    v_add_f32 v26, v34, v38
    v_add_f32 v30, v42, v46
    v_add_f32 v26, v26, v30
    v_add_f32 v27, v35, v39
    v_add_f32 v31, v43, v47
    v_add_f32 v27, v27, v31
    v_mov_b32 v15, 0x3ff
    v_bfi_b32 v24, v15, s92, v24
    v_bfi_b32 v25, v15, s93, v25
    v_bfi_b32 v26, v15, s94, v26
    v_bfi_b32 v27, v15, s95, v27
    buffer_store_dwordx4 v[24:27], v11, s[64:67], s86 offen sc1
Lsd_5:
    s_cmp_lg_u32 s76, 0
    s_cbranch_scc1 L_b6only
    s_lshr_b32 s82, s2, 5
    s_lshl_b32 s82, s82, 11
    s_and_b32 s83, s2, 7
    s_lshl_b32 s83, s83, 8
    s_add_u32 s82, s82, s83
    s_lshr_b32 s83, s2, 3
    s_and_b32 s83, s83, 3
    s_lshl_b32 s83, s83, 6
    s_add_u32 s89, s82, s83
    v_lshlrev_b32 v11, 1, v2
    buffer_load_ushort v60, v11, s[60:63], s89 offen offset:0
    buffer_load_ushort v61, v11, s[60:63], s89 offen offset:16
    buffer_load_ushort v62, v11, s[60:63], s89 offen offset:32
    buffer_load_ushort v63, v11, s[60:63], s89 offen offset:48
    v_lshrrev_b32 v5, 3, v0
    v_lshlrev_b32 v6, 17, v5
    v_lshl_add_u32 v6, v2, 4, v6
    s_lshl_b32 s86, s89, 1
    v_cmp_gt_u32 vcc, 7, v5
    v_subrev_u32 v7, 0x20000, v6
    s_nop 1
    v_cndmask_b32 v7, v7, v6, vcc
    v_cndmask_b32 v13, 0, 1.0, vcc
    s_barrier
    s_add_u32 s87, s86, 4194304
    buffer_load_dwordx4 v[16:19], v6, s[64:67], s87 offen sc1
    s_mov_b32 s88, 0
    s_waitcnt vmcnt(0)
Lmg_6:
    v_mov_b32 v8, 0
    v_xor_b32 v9, s92, v16
    v_xor_b32 v10, s93, v17
    v_or3_b32 v8, v8, v9, v10
    v_xor_b32 v9, s94, v18
    v_xor_b32 v10, s95, v19
    v_or3_b32 v8, v8, v9, v10
    v_and_b32 v8, 1023, v8
    v_cmp_ne_u32 vcc, 0, v8
    s_nop 0
    s_mov_b64 s[20:21], vcc
    s_or_b64 vcc, s[20:21], s[20:21]
    s_cbranch_scc0 Lmgd_7
    s_add_u32 s88, s88, 1
    s_cmp_ge_u32 s88, 100000
    s_cbranch_scc1 Lmgd_7
    s_sleep 4
    s_mov_b64 exec, s[20:21]
    s_cbranch_execz Lmgs_8
    s_add_u32 s87, s86, 4194304
    buffer_load_dwordx4 v[16:19], v6, s[64:67], s87 offen sc1
Lmgs_8:
    s_mov_b64 exec, -1
    s_waitcnt vmcnt(0)
    s_branch Lmg_6
Lmgd_7:
    s_add_u32 s87, s86, 4227072
    buffer_load_dwordx4 v[20:23], v6, s[64:67], s87 offen sc1
    s_add_u32 s87, s86, 4259840
    buffer_load_dwordx4 v[24:27], v6, s[64:67], s87 offen sc1
    s_add_u32 s87, s86, 4292608
    buffer_load_dwordx4 v[28:31], v6, s[64:67], s87 offen sc1
    s_add_u32 s87, s86, 5242880
    buffer_load_dwordx4 v[32:35], v7, s[64:67], s87 offen sc1
    s_add_u32 s87, s86, 5275648
    buffer_load_dwordx4 v[36:39], v7, s[64:67], s87 offen sc1
    s_add_u32 s87, s86, 5308416
    buffer_load_dwordx4 v[40:43], v7, s[64:67], s87 offen sc1
    s_add_u32 s87, s86, 5341184
    buffer_load_dwordx4 v[44:47], v7, s[64:67], s87 offen sc1
    s_mov_b32 s88, 0
    s_waitcnt vmcnt(0)
Lmg_9:
    v_mov_b32 v8, 0
    v_xor_b32 v9, s92, v20
    v_xor_b32 v10, s93, v21
    v_or3_b32 v8, v8, v9, v10
    v_xor_b32 v9, s94, v22
    v_xor_b32 v10, s95, v23
    v_or3_b32 v8, v8, v9, v10
    v_and_b32 v8, 1023, v8
    v_cmp_ne_u32 vcc, 0, v8
    s_nop 0
    s_mov_b64 s[20:21], vcc
    v_mov_b32 v8, 0
    v_xor_b32 v9, s92, v24
    v_xor_b32 v10, s93, v25
    v_or3_b32 v8, v8, v9, v10
    v_xor_b32 v9, s94, v26
    v_xor_b32 v10, s95, v27
    v_or3_b32 v8, v8, v9, v10
    v_and_b32 v8, 1023, v8
    v_cmp_ne_u32 vcc, 0, v8
    s_nop 0
    s_mov_b64 s[22:23], vcc
    v_mov_b32 v8, 0
    v_xor_b32 v9, s92, v28
    v_xor_b32 v10, s93, v29
    v_or3_b32 v8, v8, v9, v10
    v_xor_b32 v9, s94, v30
    v_xor_b32 v10, s95, v31
    v_or3_b32 v8, v8, v9, v10
    v_and_b32 v8, 1023, v8
    v_cmp_ne_u32 vcc, 0, v8
    s_nop 0
    s_mov_b64 s[24:25], vcc
    v_mov_b32 v8, 0
    v_xor_b32 v9, s92, v32
    v_xor_b32 v10, s93, v33
    v_or3_b32 v8, v8, v9, v10
    v_xor_b32 v9, s94, v34
    v_xor_b32 v10, s95, v35
    v_or3_b32 v8, v8, v9, v10
    v_and_b32 v8, 1023, v8
    v_cmp_ne_u32 vcc, 0, v8
    s_nop 0
    s_mov_b64 s[26:27], vcc
    v_mov_b32 v8, 0
    v_xor_b32 v9, s92, v36
    v_xor_b32 v10, s93, v37
    v_or3_b32 v8, v8, v9, v10
    v_xor_b32 v9, s94, v38
    v_xor_b32 v10, s95, v39
    v_or3_b32 v8, v8, v9, v10
    v_and_b32 v8, 1023, v8
    v_cmp_ne_u32 vcc, 0, v8
    s_nop 0
    s_mov_b64 s[28:29], vcc
    v_mov_b32 v8, 0
    v_xor_b32 v9, s92, v40
    v_xor_b32 v10, s93, v41
    v_or3_b32 v8, v8, v9, v10
    v_xor_b32 v9, s94, v42
    v_xor_b32 v10, s95, v43
    v_or3_b32 v8, v8, v9, v10
    v_and_b32 v8, 1023, v8
    v_cmp_ne_u32 vcc, 0, v8
    s_nop 0
    s_mov_b64 s[30:31], vcc
    v_mov_b32 v8, 0
    v_xor_b32 v9, s92, v44
    v_xor_b32 v10, s93, v45
    v_or3_b32 v8, v8, v9, v10
    v_xor_b32 v9, s94, v46
    v_xor_b32 v10, s95, v47
    v_or3_b32 v8, v8, v9, v10
    v_and_b32 v8, 1023, v8
    v_cmp_ne_u32 vcc, 0, v8
    s_nop 0
    s_mov_b64 s[32:33], vcc
    s_or_b64 vcc, s[20:21], s[20:21]
    s_or_b64 vcc, vcc, s[22:23]
    s_or_b64 vcc, vcc, s[24:25]
    s_or_b64 vcc, vcc, s[26:27]
    s_or_b64 vcc, vcc, s[28:29]
    s_or_b64 vcc, vcc, s[30:31]
    s_or_b64 vcc, vcc, s[32:33]
    s_cbranch_scc0 Lmgd_10
    s_add_u32 s88, s88, 1
    s_cmp_ge_u32 s88, 100000
    s_cbranch_scc1 Lmgd_10
    s_mov_b64 exec, s[20:21]
    s_cbranch_execz Lmgs_11
    s_add_u32 s87, s86, 4227072
    buffer_load_dwordx4 v[20:23], v6, s[64:67], s87 offen sc1
Lmgs_11:
    s_mov_b64 exec, s[22:23]
    s_cbranch_execz Lmgs_12
    s_add_u32 s87, s86, 4259840
    buffer_load_dwordx4 v[24:27], v6, s[64:67], s87 offen sc1
Lmgs_12:
    s_mov_b64 exec, s[24:25]
    s_cbranch_execz Lmgs_13
    s_add_u32 s87, s86, 4292608
    buffer_load_dwordx4 v[28:31], v6, s[64:67], s87 offen sc1
Lmgs_13:
    s_mov_b64 exec, s[26:27]
    s_cbranch_execz Lmgs_14
    s_add_u32 s87, s86, 5242880
    buffer_load_dwordx4 v[32:35], v7, s[64:67], s87 offen sc1
Lmgs_14:
    s_mov_b64 exec, s[28:29]
    s_cbranch_execz Lmgs_15
    s_add_u32 s87, s86, 5275648
    buffer_load_dwordx4 v[36:39], v7, s[64:67], s87 offen sc1
Lmgs_15:
    s_mov_b64 exec, s[30:31]
    s_cbranch_execz Lmgs_16
    s_add_u32 s87, s86, 5308416
    buffer_load_dwordx4 v[40:43], v7, s[64:67], s87 offen sc1
Lmgs_16:
    s_mov_b64 exec, s[32:33]
    s_cbranch_execz Lmgs_17
    s_add_u32 s87, s86, 5341184
    buffer_load_dwordx4 v[44:47], v7, s[64:67], s87 offen sc1
Lmgs_17:
    s_mov_b64 exec, -1
    s_waitcnt vmcnt(0)
    s_branch Lmg_9
Lmgd_10:
    v_mul_f32 v32, v32, v13
    v_mul_f32 v33, v33, v13
    v_mul_f32 v34, v34, v13
    v_mul_f32 v35, v35, v13
    v_mul_f32 v36, v36, v13
    v_mul_f32 v37, v37, v13
    v_mul_f32 v38, v38, v13
    v_mul_f32 v39, v39, v13
    v_mul_f32 v40, v40, v13
    v_mul_f32 v41, v41, v13
    v_mul_f32 v42, v42, v13
    v_mul_f32 v43, v43, v13
    v_mul_f32 v44, v44, v13
    v_mul_f32 v45, v45, v13
    v_mul_f32 v46, v46, v13
    v_mul_f32 v47, v47, v13
    v_add_f32 v16, v16, v20
    v_add_f32 v24, v24, v28
    v_add_f32 v16, v16, v24
    v_add_f32 v17, v17, v21
    v_add_f32 v25, v25, v29
    v_add_f32 v17, v17, v25
    v_add_f32 v18, v18, v22
    v_add_f32 v26, v26, v30
    v_add_f32 v18, v18, v26
    v_add_f32 v19, v19, v23
    v_add_f32 v27, v27, v31
    v_add_f32 v19, v19, v27
    v_add_f32 v32, v32, v36
    v_add_f32 v40, v40, v44
    v_add_f32 v32, v32, v40
    v_add_f32 v33, v33, v37
    v_add_f32 v41, v41, v45
    v_add_f32 v33, v33, v41
    v_add_f32 v34, v34, v38
    v_add_f32 v42, v42, v46
    v_add_f32 v34, v34, v42
    v_add_f32 v35, v35, v39
    v_add_f32 v43, v43, v47
    v_add_f32 v35, v35, v43
    s_nop 1
    v_add_f32_dpp v16, v16, v16 row_ror:8 row_mask:0xf bank_mask:0xf
    v_add_f32_dpp v17, v17, v17 row_ror:8 row_mask:0xf bank_mask:0xf
    v_add_f32_dpp v18, v18, v18 row_ror:8 row_mask:0xf bank_mask:0xf
    v_add_f32_dpp v19, v19, v19 row_ror:8 row_mask:0xf bank_mask:0xf
    v_add_f32_dpp v32, v32, v32 row_ror:8 row_mask:0xf bank_mask:0xf
    v_add_f32_dpp v33, v33, v33 row_ror:8 row_mask:0xf bank_mask:0xf
    v_add_f32_dpp v34, v34, v34 row_ror:8 row_mask:0xf bank_mask:0xf
    v_add_f32_dpp v35, v35, v35 row_ror:8 row_mask:0xf bank_mask:0xf
    v_mov_b32 v20, v16
    v_mov_b32 v21, v17
    v_mov_b32 v22, v18
    v_mov_b32 v23, v19
    v_mov_b32 v36, v32
    v_mov_b32 v37, v33
    v_mov_b32 v38, v34
    v_mov_b32 v39, v35
    s_nop 1
    v_permlane16_swap_b32 v16, v20
    v_permlane16_swap_b32 v17, v21
    v_permlane16_swap_b32 v18, v22
    v_permlane16_swap_b32 v19, v23
    v_permlane16_swap_b32 v32, v36
    v_permlane16_swap_b32 v33, v37
    v_permlane16_swap_b32 v34, v38
    v_permlane16_swap_b32 v35, v39
    s_nop 1
    v_add_f32 v16, v16, v20
    v_add_f32 v17, v17, v21
    v_add_f32 v18, v18, v22
    v_add_f32 v19, v19, v23
    v_add_f32 v32, v32, v36
    v_add_f32 v33, v33, v37
    v_add_f32 v34, v34, v38
    v_add_f32 v35, v35, v39
    v_mov_b32 v20, v16
    v_mov_b32 v21, v17
    v_mov_b32 v22, v18
    v_mov_b32 v23, v19
    v_mov_b32 v36, v32
    v_mov_b32 v37, v33
    v_mov_b32 v38, v34
    v_mov_b32 v39, v35
    s_nop 1
    v_permlane32_swap_b32 v16, v20
    v_permlane32_swap_b32 v17, v21
    v_permlane32_swap_b32 v18, v22
    v_permlane32_swap_b32 v19, v23
    v_permlane32_swap_b32 v32, v36
    v_permlane32_swap_b32 v33, v37
    v_permlane32_swap_b32 v34, v38
    v_permlane32_swap_b32 v35, v39
    s_nop 1
    v_add_f32 v16, v16, v20
    v_add_f32 v17, v17, v21
    v_add_f32 v18, v18, v22
    v_add_f32 v19, v19, v23
    v_add_f32 v32, v32, v36
    v_add_f32 v33, v33, v37
    v_add_f32 v34, v34, v38
    v_add_f32 v35, v35, v39
    v_cvt_pk_bf16_f32 v5, v16, v17
    v_lshlrev_b32 v16, 16, v5
    v_and_b32 v17, 0xffff0000, v5
    v_cvt_pk_bf16_f32 v5, v18, v19
    v_lshlrev_b32 v18, 16, v5
    v_and_b32 v19, 0xffff0000, v5
    v_cvt_pk_bf16_f32 v5, v32, v33
    v_lshlrev_b32 v32, 16, v5
    v_and_b32 v33, 0xffff0000, v5
    v_cvt_pk_bf16_f32 v5, v34, v35
    v_lshlrev_b32 v34, 16, v5
    v_and_b32 v35, 0xffff0000, v5
    v_mul_f32 v20, 0xbfb8aa3b, v32
    v_exp_f32 v20, v20
    s_nop 0
    v_add_f32 v20, 1.0, v20
    v_rcp_f32 v20, v20
    s_nop 0
    v_mul_f32 v32, v32, v20
    v_mul_f32 v21, 0xbfb8aa3b, v33
    v_exp_f32 v21, v21
    s_nop 0
    v_add_f32 v21, 1.0, v21
    v_rcp_f32 v21, v21
    s_nop 0
    v_mul_f32 v33, v33, v21
    v_mul_f32 v22, 0xbfb8aa3b, v34
    v_exp_f32 v22, v22
    s_nop 0
    v_add_f32 v22, 1.0, v22
    v_rcp_f32 v22, v22
    s_nop 0
    v_mul_f32 v34, v34, v22
    v_mul_f32 v23, 0xbfb8aa3b, v35
    v_exp_f32 v23, v23
    s_nop 0
    v_add_f32 v23, 1.0, v23
    v_rcp_f32 v23, v23
    s_nop 0
    v_mul_f32 v35, v35, v23
    v_cvt_pk_bf16_f32 v5, v32, v33
    v_lshlrev_b32 v32, 16, v5
    v_and_b32 v33, 0xffff0000, v5
    v_cvt_pk_bf16_f32 v5, v34, v35
    v_lshlrev_b32 v34, 16, v5
    v_and_b32 v35, 0xffff0000, v5
    v_mul_f32 v16, v16, v32
    v_mul_f32 v17, v17, v33
    v_mul_f32 v18, v18, v34
    v_mul_f32 v19, v19, v35
    v_cvt_pk_bf16_f32 v5, v16, v17
    v_lshlrev_b32 v16, 16, v5
    v_and_b32 v17, 0xffff0000, v5
    v_cvt_pk_bf16_f32 v5, v18, v19
    v_lshlrev_b32 v18, 16, v5
    v_and_b32 v19, 0xffff0000, v5
    v_lshlrev_b32 v60, 16, v60
    v_add_f32 v16, v16, v60
    v_lshlrev_b32 v61, 16, v61
    v_add_f32 v17, v17, v61
    v_lshlrev_b32 v62, 16, v62
    v_add_f32 v18, v18, v62
    v_lshlrev_b32 v63, 16, v63
    v_add_f32 v19, v19, v63
    v_cvt_pk_bf16_f32 v20, v16, v17
    v_cvt_pk_bf16_f32 v21, v18, v19
    s_mov_b64 exec, 0xff
    buffer_store_short v20, v11, s[72:75], s89 offen
    buffer_store_short_d16_hi v20, v11, s[72:75], s89 offen offset:16
    buffer_store_short v21, v11, s[72:75], s89 offen offset:32
    buffer_store_short_d16_hi v21, v11, s[72:75], s89 offen offset:48
    s_mov_b64 exec, -1
    s_endpgm
L_g1:
    s_mov_b32 s48, s30
    s_and_b32 s49, s31, 0xffff
    s_mov_b32 s50, 7340032
    s_mov_b32 s51, 0x20000
    s_mov_b32 s56, s24
    s_and_b32 s57, s25, 0xffff
    s_mov_b32 s58, 8388608
    s_mov_b32 s59, 0x20000
    s_cmp_ge_u32 s2, 224
    s_cselect_b32 s50, 0, s50
    s_cmp_lg_u32 s76, 7
    s_cbranch_scc1 Lnoat_18
    s_cmp_lg_u32 s2, 0
    s_cbranch_scc1 Lnoat_18
    s_memrealtime s[92:93]
    s_waitcnt lgkmcnt(0)
    s_or_b32 s93, s93, 0x80000000
    v_mov_b32 v28, s92
    v_mov_b32 v29, s93
    v_mov_b32 v12, 0
    s_mov_b64 exec, 1
    buffer_store_dwordx2 v[28:29], v12, s[68:71], 0 offen sc0 sc1
    s_mov_b64 exec, -1
Lnoat_18:
    s_lshl_b32 s82, s80, 8
    s_lshl_b32 s83, s100, 6
    s_add_u32 s82, s82, s83
    s_lshl_b32 s84, s81, 7
    s_lshl_b32 s16, s82, 13
    s_add_u32 s16, s16, s84
    s_add_u32 s84, s81, 5
    s_and_b32 s84, s84, 7
    s_and_b32 s85, s81, 0xf8
    s_or_b32 s84, s84, s85
    s_lshl_b32 s84, s84, 7
    s_mul_i32 s17, s82, 7168
    s_add_u32 s17, s17, s84
    s_lshr_b32 s18, s2, 3
    s_lshl_b32 s18, s18, 9
    buffer_load_dwordx4 v[64:67], v7, s[48:51], s17 offen offset:0 nt
    s_add_u32 s77, s17, 4096
    buffer_load_dwordx4 v[68:71], v7, s[48:51], s77 offen offset:3072 nt
    s_add_u32 s77, s17, 12288
    buffer_load_dwordx4 v[72:75], v7, s[48:51], s77 offen offset:2048 nt
    s_add_u32 s77, s17, 20480
    buffer_load_dwordx4 v[76:79], v7, s[48:51], s77 offen offset:1024 nt
    s_add_u32 s77, s17, 28672
    buffer_load_dwordx4 v[80:83], v7, s[48:51], s77 offen offset:0 nt
    s_add_u32 s77, s17, 32768
    buffer_load_dwordx4 v[84:87], v7, s[48:51], s77 offen offset:3072 nt
    s_waitcnt vmcnt(6)
    v_lshlrev_b32 v32, 16, v16
    v_and_b32 v33, 0xffff0000, v16
    v_lshlrev_b32 v34, 16, v17
    v_and_b32 v35, 0xffff0000, v17
    v_lshlrev_b32 v36, 16, v18
    v_and_b32 v37, 0xffff0000, v18
    v_lshlrev_b32 v38, 16, v19
    v_and_b32 v39, 0xffff0000, v19
    v_lshlrev_b32 v40, 16, v20
    v_and_b32 v41, 0xffff0000, v20
    v_lshlrev_b32 v42, 16, v21
    v_and_b32 v43, 0xffff0000, v21
    v_lshlrev_b32 v44, 16, v22
    v_and_b32 v45, 0xffff0000, v22
    v_lshlrev_b32 v46, 16, v23
    v_and_b32 v47, 0xffff0000, v23
    v_add_f32 v8, v32, v33
    v_add_f32 v8, v8, v34
    v_add_f32 v8, v8, v35
    v_add_f32 v8, v8, v36
    v_add_f32 v8, v8, v37
    v_add_f32 v8, v8, v38
    v_add_f32 v8, v8, v39
    v_add_f32 v8, v8, v40
    v_add_f32 v8, v8, v41
    v_add_f32 v8, v8, v42
    v_add_f32 v8, v8, v43
    v_add_f32 v8, v8, v44
    v_add_f32 v8, v8, v45
    v_add_f32 v8, v8, v46
    v_add_f32 v8, v8, v47
    s_nop 1
    v_add_f32_dpp v8, v8, v8 quad_perm:[1,0,3,2] row_mask:0xf bank_mask:0xf
    s_nop 1
    v_add_f32_dpp v8, v8, v8 quad_perm:[2,3,0,1] row_mask:0xf bank_mask:0xf
    s_nop 1
    v_add_f32_dpp v8, v8, v8 row_half_mirror row_mask:0xf bank_mask:0xf
    s_nop 1
    v_add_f32_dpp v8, v8, v8 row_mirror row_mask:0xf bank_mask:0xf
    v_mov_b32 v9, v8
    s_nop 1
    v_permlane16_swap_b32 v8, v9
    s_nop 1
    v_add_f32 v8, v8, v9
    v_mov_b32 v9, v8
    s_nop 1
    v_permlane32_swap_b32 v8, v9
    s_nop 1
    v_add_f32 v8, v8, v9
    v_mul_f32 v8, 0x3a800000, v8
    v_mov_b32 v13, 0
    v_sub_f32 v9, v32, v8
    v_fmac_f32 v13, v9, v9
    v_sub_f32 v9, v33, v8
    v_fmac_f32 v13, v9, v9
    v_sub_f32 v9, v34, v8
    v_fmac_f32 v13, v9, v9
    v_sub_f32 v9, v35, v8
    v_fmac_f32 v13, v9, v9
    v_sub_f32 v9, v36, v8
    v_fmac_f32 v13, v9, v9
    v_sub_f32 v9, v37, v8
    v_fmac_f32 v13, v9, v9
    v_sub_f32 v9, v38, v8
    v_fmac_f32 v13, v9, v9
    v_sub_f32 v9, v39, v8
    v_fmac_f32 v13, v9, v9
    v_sub_f32 v9, v40, v8
    v_fmac_f32 v13, v9, v9
    v_sub_f32 v9, v41, v8
    v_fmac_f32 v13, v9, v9
    v_sub_f32 v9, v42, v8
    v_fmac_f32 v13, v9, v9
    v_sub_f32 v9, v43, v8
    v_fmac_f32 v13, v9, v9
    v_sub_f32 v9, v44, v8
    v_fmac_f32 v13, v9, v9
    v_sub_f32 v9, v45, v8
    v_fmac_f32 v13, v9, v9
    v_sub_f32 v9, v46, v8
    v_fmac_f32 v13, v9, v9
    v_sub_f32 v9, v47, v8
    v_fmac_f32 v13, v9, v9
    s_nop 1
    v_add_f32_dpp v13, v13, v13 quad_perm:[1,0,3,2] row_mask:0xf bank_mask:0xf
    s_nop 1
    v_add_f32_dpp v13, v13, v13 quad_perm:[2,3,0,1] row_mask:0xf bank_mask:0xf
    s_nop 1
    v_add_f32_dpp v13, v13, v13 row_half_mirror row_mask:0xf bank_mask:0xf
    s_nop 1
    v_add_f32_dpp v13, v13, v13 row_mirror row_mask:0xf bank_mask:0xf
    v_mov_b32 v9, v13
    s_nop 1
    v_permlane16_swap_b32 v13, v9
    s_nop 1
    v_add_f32 v13, v13, v9
    v_mov_b32 v9, v13
    s_nop 1
    v_permlane32_swap_b32 v13, v9
    s_nop 1
    v_add_f32 v13, v13, v9
    v_mul_f32 v13, 0x3a800000, v13
    v_cvt_pk_bf16_f32 v12, v8, v13
    v_lshlrev_b32 v8, 16, v12
    v_and_b32 v13, 0xffff0000, v12
    v_add_f32 v13, 0x3727c5ac, v13
    v_cvt_pk_bf16_f32 v13, v13, v13
    v_and_b32 v13, 0xffff0000, v13
    v_sqrt_f32 v13, v13
    s_nop 0
    v_cvt_pk_bf16_f32 v13, v13, v13
    v_and_b32 v13, 0xffff0000, v13
    v_rcp_f32 v12, v13
    s_nop 0
    v_fma_f32 v9, -v13, v12, 1.0
    v_fma_f32 v12, v9, v12, v12
    v_sub_f32 v32, v32, v8
    v_sub_f32 v33, v33, v8
    v_cvt_pk_bf16_f32 v9, v32, v33
    v_lshlrev_b32 v32, 16, v9
    v_and_b32 v33, 0xffff0000, v9
    v_mul_f32 v32, v32, v12
    v_mul_f32 v33, v33, v12
    v_cvt_pk_bf16_f32 v16, v32, v33
    v_sub_f32 v34, v34, v8
    v_sub_f32 v35, v35, v8
    v_cvt_pk_bf16_f32 v9, v34, v35
    v_lshlrev_b32 v34, 16, v9
    v_and_b32 v35, 0xffff0000, v9
    v_mul_f32 v34, v34, v12
    v_mul_f32 v35, v35, v12
    v_cvt_pk_bf16_f32 v17, v34, v35
    v_sub_f32 v36, v36, v8
    v_sub_f32 v37, v37, v8
    v_cvt_pk_bf16_f32 v9, v36, v37
    v_lshlrev_b32 v36, 16, v9
    v_and_b32 v37, 0xffff0000, v9
    v_mul_f32 v36, v36, v12
    v_mul_f32 v37, v37, v12
    v_cvt_pk_bf16_f32 v18, v36, v37
    v_sub_f32 v38, v38, v8
    v_sub_f32 v39, v39, v8
    v_cvt_pk_bf16_f32 v9, v38, v39
    v_lshlrev_b32 v38, 16, v9
    v_and_b32 v39, 0xffff0000, v9
    v_mul_f32 v38, v38, v12
    v_mul_f32 v39, v39, v12
    v_cvt_pk_bf16_f32 v19, v38, v39
    v_sub_f32 v40, v40, v8
    v_sub_f32 v41, v41, v8
    v_cvt_pk_bf16_f32 v9, v40, v41
    v_lshlrev_b32 v40, 16, v9
    v_and_b32 v41, 0xffff0000, v9
    v_mul_f32 v40, v40, v12
    v_mul_f32 v41, v41, v12
    v_cvt_pk_bf16_f32 v20, v40, v41
    v_sub_f32 v42, v42, v8
    v_sub_f32 v43, v43, v8
    v_cvt_pk_bf16_f32 v9, v42, v43
    v_lshlrev_b32 v42, 16, v9
    v_and_b32 v43, 0xffff0000, v9
    v_mul_f32 v42, v42, v12
    v_mul_f32 v43, v43, v12
    v_cvt_pk_bf16_f32 v21, v42, v43
    v_sub_f32 v44, v44, v8
    v_sub_f32 v45, v45, v8
    v_cvt_pk_bf16_f32 v9, v44, v45
    v_lshlrev_b32 v44, 16, v9
    v_and_b32 v45, 0xffff0000, v9
    v_mul_f32 v44, v44, v12
    v_mul_f32 v45, v45, v12
    v_cvt_pk_bf16_f32 v22, v44, v45
    v_sub_f32 v46, v46, v8
    v_sub_f32 v47, v47, v8
    v_cvt_pk_bf16_f32 v9, v46, v47
    v_lshlrev_b32 v46, 16, v9
    v_and_b32 v47, 0xffff0000, v9
    v_mul_f32 v46, v46, v12
    v_mul_f32 v47, v47, v12
    v_cvt_pk_bf16_f32 v23, v46, v47
    v_cmp_eq_u32 vcc, s80, v1
    v_and_b32 v9, 15, v0
    v_lshlrev_b32 v9, 5, v9
    s_lshl_b32 s83, s76, 9
    v_add_u32 v9, s83, v9
    s_mov_b64 exec, vcc
    ds_write_b128 v9, v[16:19] offset:49152
    ds_write_b128 v9, v[20:23] offset:49168
    s_mov_b64 exec, -1
    v_lshlrev_b32 v8, 9, v2
    v_lshl_add_u32 v8, v11, 1, v8
    s_lshl_b32 s83, s100, 7
    v_add_u32 v8, s83, v8
    s_waitcnt lgkmcnt(0)
    s_barrier
    ds_read_b128 v[16:19], v8 offset:49152
    v_mov_b32 v24, 0
    s_cmp_lg_u32 s76, 7
    s_cbranch_scc1 Lnopl_19
    buffer_load_dwordx2 v[28:29], v24, s[68:71], 0 offen sc0 sc1
Lnopl_19:
    s_waitcnt vmcnt(4)
    s_add_u32 s77, s17, 40960
    buffer_load_dwordx4 v[88:91], v7, s[48:51], s77 offen offset:2048 nt
    s_add_u32 s77, s17, 49152
    buffer_load_dwordx4 v[92:95], v7, s[48:51], s77 offen offset:1024 nt
    s_waitcnt vmcnt(4)
    buffer_load_dwordx4 v[128:131], v4, s[40:43], s89 offen offset:0 nt
    buffer_load_dwordx4 v[132:135], v4, s[40:43], s89 offen offset:64 nt
    s_waitcnt vmcnt(4)
    buffer_load_dwordx4 v[136:139], v4, s[40:43], s89 offen offset:128 nt
    buffer_load_dwordx4 v[140:143], v4, s[40:43], s89 offen offset:192 nt
    s_waitcnt vmcnt(4)
    s_add_u32 s77, s89, 4096
    buffer_load_dwordx4 v[144:147], v4, s[40:43], s77 offen offset:0 nt
    s_add_u32 s77, s89, 4096
    buffer_load_dwordx4 v[148:151], v4, s[40:43], s77 offen offset:64 nt
    s_waitcnt vmcnt(6) lgkmcnt(0)
    v_perm_b32 v8, v68, v64, s78
    v_perm_b32 v9, v76, v72, s78
    v_perm_b32 v10, v84, v80, s78
    v_perm_b32 v11, v92, v88, s78
    v_perm_b32 v12, v68, v64, s79
    v_perm_b32 v13, v76, v72, s79
    v_perm_b32 v14, v84, v80, s79
    v_perm_b32 v15, v92, v88, s79
    v_mfma_f32_16x16x32_bf16 v[32:35], v[8:11], v[16:19], 0
    v_perm_b32 v8, v69, v65, s78
    v_perm_b32 v9, v77, v73, s78
    v_perm_b32 v10, v85, v81, s78
    v_perm_b32 v11, v93, v89, s78
    v_mfma_f32_16x16x32_bf16 v[36:39], v[12:15], v[16:19], 0
    v_perm_b32 v12, v69, v65, s79
    v_perm_b32 v13, v77, v73, s79
    v_perm_b32 v14, v85, v81, s79
    v_perm_b32 v15, v93, v89, s79
    v_mfma_f32_16x16x32_bf16 v[40:43], v[8:11], v[16:19], 0
    v_perm_b32 v8, v70, v66, s78
    v_perm_b32 v9, v78, v74, s78
    v_perm_b32 v10, v86, v82, s78
    v_perm_b32 v11, v94, v90, s78
    v_mfma_f32_16x16x32_bf16 v[44:47], v[12:15], v[16:19], 0
    v_perm_b32 v12, v70, v66, s79
    v_perm_b32 v13, v78, v74, s79
    v_perm_b32 v14, v86, v82, s79
    v_perm_b32 v15, v94, v90, s79
    v_mfma_f32_16x16x32_bf16 v[48:51], v[8:11], v[16:19], 0
    v_perm_b32 v8, v71, v67, s78
    v_perm_b32 v9, v79, v75, s78
    v_perm_b32 v10, v87, v83, s78
    v_perm_b32 v11, v95, v91, s78
    v_mfma_f32_16x16x32_bf16 v[52:55], v[12:15], v[16:19], 0
    v_perm_b32 v12, v71, v67, s79
    v_perm_b32 v13, v79, v75, s79
    v_perm_b32 v14, v87, v83, s79
    v_perm_b32 v15, v95, v91, s79
    v_mfma_f32_16x16x32_bf16 v[56:59], v[8:11], v[16:19], 0
    s_nop 1
    v_mfma_f32_16x16x32_bf16 v[60:63], v[12:15], v[16:19], 0
    s_lshl_b32 s83, s100, 12
    s_add_u32 s83, s83, 0
    v_lshlrev_b32 v8, 7, v1
    v_lshl_add_u32 v8, v2, 4, v8
    v_add_u32 v8, s83, v8
    s_mov_b64 exec, s[96:97]
    s_nop 5
    ds_write_b128 v8, v[32:35] offset:32768
    ds_write_b128 v8, v[36:39] offset:33280
    ds_write_b128 v8, v[40:43] offset:33792
    ds_write_b128 v8, v[44:47] offset:34304
    ds_write_b128 v8, v[48:51] offset:34816
    ds_write_b128 v8, v[52:55] offset:35328
    ds_write_b128 v8, v[56:59] offset:35840
    ds_write_b128 v8, v[60:63] offset:36352
    s_mov_b64 exec, -1
    s_cmp_lg_u32 s76, 7
    s_cbranch_scc1 Lnoep_20
    s_mov_b32 s88, 0
Lep_21:
    v_readfirstlane_b32 s83, v29
    s_nop 3
    s_cmp_lt_i32 s83, 0
    s_cbranch_scc1 Lepd_22
    s_add_u32 s88, s88, 1
    s_cmp_ge_u32 s88, 100000
    s_cbranch_scc1 Lepd_22
    buffer_load_dwordx2 v[28:29], v24, s[68:71], 0 offen sc0 sc1
    s_waitcnt vmcnt(0)
    s_branch Lep_21
Lepd_22:
    v_mov_b32 v8, 59904
    s_mov_b64 exec, 1
    ds_write_b64 v8, v[28:29]
    s_mov_b64 exec, -1
Lnoep_20:
    s_waitcnt vmcnt(4)
    s_add_u32 s77, s89, 4096
    buffer_load_dwordx4 v[152:155], v4, s[40:43], s77 offen offset:128 nt
    s_add_u32 s77, s89, 4096
    buffer_load_dwordx4 v[156:159], v4, s[40:43], s77 offen offset:192 nt
    s_waitcnt vmcnt(4)
    s_add_u32 s77, s89, 8192
    buffer_load_dwordx4 v[160:163], v4, s[40:43], s77 offen offset:0 nt
    s_add_u32 s77, s89, 8192
    buffer_load_dwordx4 v[164:167], v4, s[40:43], s77 offen offset:64 nt
    s_waitcnt vmcnt(4)
    s_add_u32 s77, s89, 8192
    buffer_load_dwordx4 v[168:171], v4, s[40:43], s77 offen offset:128 nt
    s_add_u32 s77, s89, 8192
    buffer_load_dwordx4 v[172:175], v4, s[40:43], s77 offen offset:192 nt
    s_waitcnt vmcnt(4)
    s_add_u32 s77, s89, 12288
    buffer_load_dwordx4 v[176:179], v4, s[40:43], s77 offen offset:0 nt
    s_add_u32 s77, s89, 12288
    buffer_load_dwordx4 v[180:183], v4, s[40:43], s77 offen offset:64 nt
    s_waitcnt vmcnt(6)
    s_lshl_b32 s83, s100, 6
    v_add_u32 v12, s83, v0
    v_lshrrev_b32 v6, 5, v12
    v_lshlrev_b32 v6, 14, v6
    v_and_b32 v9, 31, v12
    v_lshl_add_u32 v6, v9, 4, v6
    v_and_b32 v9, 15, v0
    v_lshlrev_b32 v7, 14, v1
    v_lshl_add_u32 v7, v9, 4, v7
    s_add_u32 s77, s89, 12288
    buffer_load_dwordx4 v[184:187], v4, s[40:43], s77 offen offset:128 nt
    s_add_u32 s77, s89, 12288
    buffer_load_dwordx4 v[188:191], v4, s[40:43], s77 offen offset:192 nt
    buffer_load_dwordx4 v[192:195], v5, s[44:47], s89 offen offset:0 nt
    buffer_load_dwordx4 v[196:199], v5, s[44:47], s89 offen offset:256 nt
    s_waitcnt lgkmcnt(0)
    s_barrier
    v_mov_b32 v8, 59904
    ds_read_b64 v[28:29], v8
    s_waitcnt lgkmcnt(0)
    v_readfirstlane_b32 s82, v28
    v_readfirstlane_b32 s83, v29
    s_nop 3
    s_and_b32 s92, s82, 1023
    s_bfe_u32 s93, s82, 0xa000a
    s_bfe_u32 s94, s82, 0xa0014
    s_lshr_b32 s95, s82, 30
    s_and_b32 s83, s83, 0xff
    s_lshl_b32 s83, s83, 2
    s_or_b32 s95, s95, s83
    s_cmp_ge_u32 s2, 224
    s_cbranch_scc1 Lsk_23
    s_cmp_lt_u32 s76, 4
    s_cbranch_scc1 Lsk_23
    s_cmp_ge_u32 s76, 6
    s_cbranch_scc1 Lsk_23
    s_lshr_b32 s82, s76, 1
    s_and_b32 s83, s76, 1
    s_lshl_b32 s84, s82, 14
    s_lshl_b32 s85, s83, 9
    s_add_u32 s84, s84, s85
    v_lshlrev_b32 v8, 10, v1
    v_lshl_add_u32 v8, v3, 7, v8
    v_lshl_add_u32 v8, v2, 4, v8
    v_add_u32 v8, s84, v8
    ds_read_b128 v[32:35], v8 offset:0
    ds_read_b128 v[36:39], v8 offset:256
    ds_read_b128 v[40:43], v8 offset:4096
    ds_read_b128 v[44:47], v8 offset:4352
    ds_read_b128 v[48:51], v8 offset:8192
    ds_read_b128 v[52:55], v8 offset:8448
    ds_read_b128 v[56:59], v8 offset:12288
    ds_read_b128 v[60:63], v8 offset:12544
    s_cmp_eq_u32 s82, 1
    s_cselect_b32 s86, 2, 0
    s_cmp_eq_u32 s82, 2
    s_cselect_b32 s86, 5, s86
    s_add_u32 s86, s86, s81
    s_and_b32 s86, s86, 7
    s_and_b32 s87, s81, 0xf8
    s_or_b32 s86, s86, s87
    s_lshl_b32 s84, s82, 19
    s_lshl_b32 s85, s80, 17
    s_add_u32 s84, s84, s85
    s_lshl_b32 s85, s86, 8
    s_add_u32 s84, s84, s85
    s_lshl_b32 s85, s83, 4
    s_add_u32 s84, s84, s85
    v_lshlrev_b32 v9, 14, v2
    v_lshl_add_u32 v9, v3, 7, v9
    v_lshl_add_u32 v9, v1, 5, v9
    s_waitcnt lgkmcnt(0)
    v_add_f32 v24, v32, v36
    v_add_f32 v24, v24, v40
    v_add_f32 v24, v24, v44
    v_add_f32 v24, v24, v48
    v_add_f32 v24, v24, v52
    v_add_f32 v24, v24, v56
    v_add_f32 v24, v24, v60
    v_add_f32 v25, v33, v37
    v_add_f32 v25, v25, v41
    v_add_f32 v25, v25, v45
    v_add_f32 v25, v25, v49
    v_add_f32 v25, v25, v53
    v_add_f32 v25, v25, v57
    v_add_f32 v25, v25, v61
    v_add_f32 v26, v34, v38
    v_add_f32 v26, v26, v42
    v_add_f32 v26, v26, v46
    v_add_f32 v26, v26, v50
    v_add_f32 v26, v26, v54
    v_add_f32 v26, v26, v58
    v_add_f32 v26, v26, v62
    v_add_f32 v27, v35, v39
    v_add_f32 v27, v27, v43
    v_add_f32 v27, v27, v47
    v_add_f32 v27, v27, v51
    v_add_f32 v27, v27, v55
    v_add_f32 v27, v27, v59
    v_add_f32 v27, v27, v63
    v_mov_b32 v15, 0xff
    v_bfi_b32 v24, v15, s92, v24
    v_bfi_b32 v25, v15, s93, v25
    v_bfi_b32 v26, v15, s94, v26
    v_bfi_b32 v27, v15, s95, v27
    buffer_store_dwordx4 v[24:27], v9, s[64:67], s84 offen sc1
Lsk_23:
    s_waitcnt vmcnt(4)
    buffer_load_dwordx4 v[200:203], v5, s[44:47], s89 offen offset:512 nt
    buffer_load_dwordx4 v[204:207], v5, s[44:47], s89 offen offset:768 nt
    s_waitcnt vmcnt(4)
    s_add_u32 s77, s89, 4096
    buffer_load_dwordx4 v[208:211], v5, s[44:47], s77 offen offset:0 nt
    s_add_u32 s77, s89, 4096
    buffer_load_dwordx4 v[212:215], v5, s[44:47], s77 offen offset:256 nt
    s_waitcnt vmcnt(4)
    s_add_u32 s77, s89, 4096
    buffer_load_dwordx4 v[216:219], v5, s[44:47], s77 offen offset:512 nt
    s_add_u32 s77, s89, 4096
    buffer_load_dwordx4 v[220:223], v5, s[44:47], s77 offen offset:768 nt
    s_waitcnt vmcnt(4)
    s_add_u32 s77, s18, 524288
    buffer_load_dwordx4 v[96:99], v6, s[64:67], s77 offen sc1
    s_add_u32 s77, s18, 655360
    buffer_load_dwordx4 v[100:103], v6, s[64:67], s77 offen sc1
    s_waitcnt vmcnt(4)
    s_add_u32 s77, s18, 786432
    buffer_load_dwordx4 v[104:107], v6, s[64:67], s77 offen sc1
    s_add_u32 s77, s18, 917504
    buffer_load_dwordx4 v[108:111], v6, s[64:67], s77 offen sc1
    s_waitcnt vmcnt(4)
    s_add_u32 s77, s18, 1048576
    buffer_load_dwordx4 v[112:115], v6, s[64:67], s77 offen sc1
    s_add_u32 s77, s18, 1179648
    buffer_load_dwordx4 v[116:119], v6, s[64:67], s77 offen sc1
    s_waitcnt vmcnt(4)
    s_add_u32 s77, s18, 1310720
    buffer_load_dwordx4 v[120:123], v6, s[64:67], s77 offen sc1
    s_add_u32 s77, s18, 1441792
    buffer_load_dwordx4 v[124:127], v6, s[64:67], s77 offen sc1
    s_waitcnt vmcnt(4)
    s_add_u32 s77, s89, 8192
    buffer_load_dwordx4 v[224:227], v5, s[44:47], s77 offen offset:0 nt
    s_add_u32 s77, s89, 8192
    buffer_load_dwordx4 v[228:231], v5, s[44:47], s77 offen offset:256 nt
    s_waitcnt vmcnt(4)
    s_add_u32 s77, s89, 8192
    buffer_load_dwordx4 v[232:235], v5, s[44:47], s77 offen offset:512 nt
    s_add_u32 s77, s89, 8192
    buffer_load_dwordx4 v[236:239], v5, s[44:47], s77 offen offset:768 nt
    s_waitcnt vmcnt(4)
    s_add_u32 s77, s89, 12288
    buffer_load_dwordx4 v[240:243], v5, s[44:47], s77 offen offset:0 nt
    s_add_u32 s77, s89, 12288
    buffer_load_dwordx4 v[244:247], v5, s[44:47], s77 offen offset:256 nt
    s_cmp_ge_u32 s2, 224
    s_cbranch_scc1 Lskh_24
    s_mov_b32 s88, 0
    s_waitcnt vmcnt(6)
Lchk_25:
    v_mov_b32 v8, 0
    v_xor_b32 v9, s92, v96
    v_xor_b32 v10, s93, v97
    v_or3_b32 v8, v8, v9, v10
    v_xor_b32 v9, s94, v98
    v_xor_b32 v10, s95, v99
    v_or3_b32 v8, v8, v9, v10
    v_xor_b32 v9, s92, v100
    v_xor_b32 v10, s93, v101
    v_or3_b32 v8, v8, v9, v10
    v_xor_b32 v9, s94, v102
    v_xor_b32 v10, s95, v103
    v_or3_b32 v8, v8, v9, v10
    v_xor_b32 v9, s92, v104
    v_xor_b32 v10, s93, v105
    v_or3_b32 v8, v8, v9, v10
    v_xor_b32 v9, s94, v106
    v_xor_b32 v10, s95, v107
    v_or3_b32 v8, v8, v9, v10
    v_xor_b32 v9, s92, v108
    v_xor_b32 v10, s93, v109
    v_or3_b32 v8, v8, v9, v10
    v_xor_b32 v9, s94, v110
    v_xor_b32 v10, s95, v111
    v_or3_b32 v8, v8, v9, v10
    v_xor_b32 v9, s92, v112
    v_xor_b32 v10, s93, v113
    v_or3_b32 v8, v8, v9, v10
    v_xor_b32 v9, s94, v114
    v_xor_b32 v10, s95, v115
    v_or3_b32 v8, v8, v9, v10
    v_xor_b32 v9, s92, v116
    v_xor_b32 v10, s93, v117
    v_or3_b32 v8, v8, v9, v10
    v_xor_b32 v9, s94, v118
    v_xor_b32 v10, s95, v119
    v_or3_b32 v8, v8, v9, v10
    v_xor_b32 v9, s92, v120
    v_xor_b32 v10, s93, v121
    v_or3_b32 v8, v8, v9, v10
    v_xor_b32 v9, s94, v122
    v_xor_b32 v10, s95, v123
    v_or3_b32 v8, v8, v9, v10
    v_xor_b32 v9, s92, v124
    v_xor_b32 v10, s93, v125
    v_or3_b32 v8, v8, v9, v10
    v_xor_b32 v9, s94, v126
    v_xor_b32 v10, s95, v127
    v_or3_b32 v8, v8, v9, v10
    v_and_b32 v8, 255, v8
    v_cmp_ne_u32 vcc, 0, v8
    s_cbranch_vccz Lok_26
    s_add_u32 s88, s88, 1
    s_cmp_ge_u32 s88, 100000
    s_cbranch_scc1 Lok_26
    s_mov_b64 exec, vcc
    s_add_u32 s77, s18, 524288
    buffer_load_dwordx4 v[96:99], v6, s[64:67], s77 offen sc1
    s_add_u32 s77, s18, 655360
    buffer_load_dwordx4 v[100:103], v6, s[64:67], s77 offen sc1
    s_add_u32 s77, s18, 786432
    buffer_load_dwordx4 v[104:107], v6, s[64:67], s77 offen sc1
    s_add_u32 s77, s18, 917504
    buffer_load_dwordx4 v[108:111], v6, s[64:67], s77 offen sc1
    s_add_u32 s77, s18, 1048576
    buffer_load_dwordx4 v[112:115], v6, s[64:67], s77 offen sc1
    s_add_u32 s77, s18, 1179648
    buffer_load_dwordx4 v[116:119], v6, s[64:67], s77 offen sc1
    s_add_u32 s77, s18, 1310720
    buffer_load_dwordx4 v[120:123], v6, s[64:67], s77 offen sc1
    s_add_u32 s77, s18, 1441792
    buffer_load_dwordx4 v[124:127], v6, s[64:67], s77 offen sc1
    s_waitcnt vmcnt(0)
    s_mov_b64 exec, -1
    s_branch Lchk_25
Lok_26:
    s_lshl_b32 s83, s100, 6
    v_add_u32 v12, s83, v0
    v_lshrrev_b32 v14, 4, v12
    v_lshlrev_b32 v14, 7, v14
    v_lshl_add_u32 v14, v3, 6, v14
    v_lshl_add_u32 v14, v2, 1, v14
    v_add_f32 v96, v96, v100
    v_add_f32 v104, v104, v108
    v_add_f32 v96, v96, v104
    v_add_f32 v97, v97, v101
    v_add_f32 v105, v105, v109
    v_add_f32 v97, v97, v105
    v_add_f32 v98, v98, v102
    v_add_f32 v106, v106, v110
    v_add_f32 v98, v98, v106
    v_add_f32 v99, v99, v103
    v_add_f32 v107, v107, v111
    v_add_f32 v99, v99, v107
    v_add_f32 v112, v112, v116
    v_add_f32 v120, v120, v124
    v_add_f32 v112, v112, v120
    v_add_f32 v113, v113, v117
    v_add_f32 v121, v121, v125
    v_add_f32 v113, v113, v121
    v_add_f32 v114, v114, v118
    v_add_f32 v122, v122, v126
    v_add_f32 v114, v114, v122
    v_add_f32 v115, v115, v119
    v_add_f32 v123, v123, v127
    v_add_f32 v115, v115, v123
    v_cvt_pk_bf16_f32 v8, v96, v97
    v_lshlrev_b32 v96, 16, v8
    v_and_b32 v97, 0xffff0000, v8
    v_cvt_pk_bf16_f32 v8, v98, v99
    v_lshlrev_b32 v98, 16, v8
    v_and_b32 v99, 0xffff0000, v8
    v_cvt_pk_bf16_f32 v8, v112, v113
    v_lshlrev_b32 v112, 16, v8
    v_and_b32 v113, 0xffff0000, v8
    v_cvt_pk_bf16_f32 v8, v114, v115
    v_lshlrev_b32 v114, 16, v8
    v_and_b32 v115, 0xffff0000, v8
    v_mul_f32 v96, 0xbfb8aa3b, v96
    v_exp_f32 v96, v96
    s_nop 0
    v_add_f32 v96, 1.0, v96
    v_rcp_f32 v96, v96
    s_nop 0
    v_mul_f32 v97, 0xbfb8aa3b, v97
    v_exp_f32 v97, v97
    s_nop 0
    v_add_f32 v97, 1.0, v97
    v_rcp_f32 v97, v97
    s_nop 0
    v_mul_f32 v98, 0xbfb8aa3b, v98
    v_exp_f32 v98, v98
    s_nop 0
    v_add_f32 v98, 1.0, v98
    v_rcp_f32 v98, v98
    s_nop 0
    v_mul_f32 v99, 0xbfb8aa3b, v99
    v_exp_f32 v99, v99
    s_nop 0
    v_add_f32 v99, 1.0, v99
    v_rcp_f32 v99, v99
    s_nop 0
    v_cvt_pk_bf16_f32 v8, v96, v97
    v_lshlrev_b32 v96, 16, v8
    v_and_b32 v97, 0xffff0000, v8
    v_cvt_pk_bf16_f32 v8, v98, v99
    v_lshlrev_b32 v98, 16, v8
    v_and_b32 v99, 0xffff0000, v8
    v_mul_f32 v96, v96, v112
    v_mul_f32 v97, v97, v113
    v_mul_f32 v98, v98, v114
    v_mul_f32 v99, v99, v115
    v_cvt_pk_bf16_f32 v8, v96, v97
    v_cvt_pk_bf16_f32 v9, v98, v99
    ds_write_b16 v14, v8 offset:55296
    ds_write_b16_d16_hi v14, v8 offset:55312
    ds_write_b16 v14, v9 offset:55328
    ds_write_b16_d16_hi v14, v9 offset:55344
Lskh_24:
    s_add_u32 s77, s89, 12288
    buffer_load_dwordx4 v[248:251], v5, s[44:47], s77 offen offset:512 nt
    s_add_u32 s77, s89, 12288
    buffer_load_dwordx4 v[252:255], v5, s[44:47], s77 offen offset:768 nt
    s_waitcnt lgkmcnt(0)
    s_barrier
    v_lshlrev_b32 v8, 8, v2
    v_lshl_add_u32 v8, v1, 4, v8
    ds_read_b128 v[16:19], v8 offset:53248
    ds_read_b128 v[20:23], v8 offset:53312
    ds_read_b128 v[24:27], v8 offset:53376
    ds_read_b128 v[28:31], v8 offset:53440
    s_waitcnt vmcnt(24) lgkmcnt(0)
    v_mfma_f32_16x16x32_bf16 v[32:35], v[128:131], v[16:19], 0
    v_mfma_f32_16x16x32_bf16 v[36:39], v[144:147], v[16:19], 0
    v_mfma_f32_16x16x32_bf16 v[32:35], v[132:135], v[20:23], v[32:35]
    v_mfma_f32_16x16x32_bf16 v[36:39], v[148:151], v[20:23], v[36:39]
    v_mfma_f32_16x16x32_bf16 v[32:35], v[136:139], v[24:27], v[32:35]
    v_mfma_f32_16x16x32_bf16 v[36:39], v[152:155], v[24:27], v[36:39]
    v_mfma_f32_16x16x32_bf16 v[32:35], v[140:143], v[28:31], v[32:35]
    v_mfma_f32_16x16x32_bf16 v[36:39], v[156:159], v[28:31], v[36:39]
    v_mfma_f32_16x16x32_bf16 v[40:43], v[160:163], v[16:19], 0
    v_mfma_f32_16x16x32_bf16 v[44:47], v[176:179], v[16:19], 0
    v_mfma_f32_16x16x32_bf16 v[40:43], v[164:167], v[20:23], v[40:43]
    v_mfma_f32_16x16x32_bf16 v[44:47], v[180:183], v[20:23], v[44:47]
    v_mfma_f32_16x16x32_bf16 v[40:43], v[168:171], v[24:27], v[40:43]
    v_mfma_f32_16x16x32_bf16 v[44:47], v[184:187], v[24:27], v[44:47]
    v_mfma_f32_16x16x32_bf16 v[40:43], v[172:175], v[28:31], v[40:43]
    v_mfma_f32_16x16x32_bf16 v[44:47], v[188:191], v[28:31], v[44:47]
    s_nop 7
    s_mov_b32 s82, 0x3db504f3
    v_cvt_pk_bf16_f32 v8, v32, v33
    v_lshlrev_b32 v32, 16, v8
    v_and_b32 v33, 0xffff0000, v8
    v_mul_f32 v32, s82, v32
    v_mul_f32 v33, s82, v33
    v_cvt_pk_bf16_f32 v8, v32, v33
    v_lshlrev_b32 v32, 16, v8
    v_and_b32 v33, 0xffff0000, v8
    v_cvt_pk_bf16_f32 v8, v34, v35
    v_lshlrev_b32 v34, 16, v8
    v_and_b32 v35, 0xffff0000, v8
    v_mul_f32 v34, s82, v34
    v_mul_f32 v35, s82, v35
    v_cvt_pk_bf16_f32 v8, v34, v35
    v_lshlrev_b32 v34, 16, v8
    v_and_b32 v35, 0xffff0000, v8
    v_cvt_pk_bf16_f32 v8, v36, v37
    v_lshlrev_b32 v36, 16, v8
    v_and_b32 v37, 0xffff0000, v8
    v_mul_f32 v36, s82, v36
    v_mul_f32 v37, s82, v37
    v_cvt_pk_bf16_f32 v8, v36, v37
    v_lshlrev_b32 v36, 16, v8
    v_and_b32 v37, 0xffff0000, v8
    v_cvt_pk_bf16_f32 v8, v38, v39
    v_lshlrev_b32 v38, 16, v8
    v_and_b32 v39, 0xffff0000, v8
    v_mul_f32 v38, s82, v38
    v_mul_f32 v39, s82, v39
    v_cvt_pk_bf16_f32 v8, v38, v39
    v_lshlrev_b32 v38, 16, v8
    v_and_b32 v39, 0xffff0000, v8
    v_cvt_pk_bf16_f32 v8, v40, v41
    v_lshlrev_b32 v40, 16, v8
    v_and_b32 v41, 0xffff0000, v8
    v_mul_f32 v40, s82, v40
    v_mul_f32 v41, s82, v41
    v_cvt_pk_bf16_f32 v8, v40, v41
    v_lshlrev_b32 v40, 16, v8
    v_and_b32 v41, 0xffff0000, v8
    v_cvt_pk_bf16_f32 v8, v42, v43
    v_lshlrev_b32 v42, 16, v8
    v_and_b32 v43, 0xffff0000, v8
    v_mul_f32 v42, s82, v42
    v_mul_f32 v43, s82, v43
    v_cvt_pk_bf16_f32 v8, v42, v43
    v_lshlrev_b32 v42, 16, v8
    v_and_b32 v43, 0xffff0000, v8
    v_cvt_pk_bf16_f32 v8, v44, v45
    v_lshlrev_b32 v44, 16, v8
    v_and_b32 v45, 0xffff0000, v8
    v_mul_f32 v44, s82, v44
    v_mul_f32 v45, s82, v45
    v_cvt_pk_bf16_f32 v8, v44, v45
    v_lshlrev_b32 v44, 16, v8
    v_and_b32 v45, 0xffff0000, v8
    v_cvt_pk_bf16_f32 v8, v46, v47
    v_lshlrev_b32 v46, 16, v8
    v_and_b32 v47, 0xffff0000, v8
    v_mul_f32 v46, s82, v46
    v_mul_f32 v47, s82, v47
    v_cvt_pk_bf16_f32 v8, v46, v47
    v_lshlrev_b32 v46, 16, v8
    v_and_b32 v47, 0xffff0000, v8
    s_mov_b32 s91, 0x3fb8aa3b
    v_max3_f32 v8, v32, v33, v34
    v_max3_f32 v8, v8, v35, v36
    v_max3_f32 v8, v8, v37, v38
    v_max3_f32 v8, v8, v39, v40
    v_max3_f32 v8, v8, v41, v42
    v_max3_f32 v8, v8, v43, v44
    v_max3_f32 v8, v8, v45, v46
    v_max_f32 v8, v8, v47
    v_mov_b32 v9, v8
    s_nop 1
    v_permlane16_swap_b32 v8, v9
    s_nop 1
    v_max_f32 v8, v8, v9
    v_mov_b32 v9, v8
    s_nop 1
    v_permlane32_swap_b32 v8, v9
    s_nop 1
    v_max_f32 v8, v8, v9
    v_mul_f32 v8, s91, v8
    v_fma_f32 v32, v32, s91, -v8
    v_fma_f32 v33, v33, s91, -v8
    v_fma_f32 v34, v34, s91, -v8
    v_fma_f32 v35, v35, s91, -v8
    v_fma_f32 v36, v36, s91, -v8
    v_fma_f32 v37, v37, s91, -v8
    v_fma_f32 v38, v38, s91, -v8
    v_fma_f32 v39, v39, s91, -v8
    v_fma_f32 v40, v40, s91, -v8
    v_fma_f32 v41, v41, s91, -v8
    v_fma_f32 v42, v42, s91, -v8
    v_fma_f32 v43, v43, s91, -v8
    v_fma_f32 v44, v44, s91, -v8
    v_fma_f32 v45, v45, s91, -v8
    v_fma_f32 v46, v46, s91, -v8
    v_fma_f32 v47, v47, s91, -v8
    v_exp_f32 v32, v32
    v_exp_f32 v33, v33
    v_exp_f32 v34, v34
    v_exp_f32 v35, v35
    v_exp_f32 v36, v36
    v_exp_f32 v37, v37
    v_exp_f32 v38, v38
    v_exp_f32 v39, v39
    v_exp_f32 v40, v40
    v_exp_f32 v41, v41
    v_exp_f32 v42, v42
    v_exp_f32 v43, v43
    v_exp_f32 v44, v44
    v_exp_f32 v45, v45
    v_exp_f32 v46, v46
    v_exp_f32 v47, v47
    s_nop 0
    v_cvt_pk_bf16_f32 v16, v32, v33
    v_cvt_pk_bf16_f32 v17, v34, v35
    v_cvt_pk_bf16_f32 v18, v36, v37
    v_cvt_pk_bf16_f32 v19, v38, v39
    v_cvt_pk_bf16_f32 v20, v40, v41
    v_cvt_pk_bf16_f32 v21, v42, v43
    v_cvt_pk_bf16_f32 v22, v44, v45
    v_cvt_pk_bf16_f32 v23, v46, v47
    v_mov_b32 v9, 0
    v_lshlrev_b32 v10, 16, v16
    v_and_b32 v11, 0xffff0000, v16
    v_add_f32 v9, v9, v10
    v_add_f32 v9, v9, v11
    v_lshlrev_b32 v10, 16, v17
    v_and_b32 v11, 0xffff0000, v17
    v_add_f32 v9, v9, v10
    v_add_f32 v9, v9, v11
    v_lshlrev_b32 v10, 16, v18
    v_and_b32 v11, 0xffff0000, v18
    v_add_f32 v9, v9, v10
    v_add_f32 v9, v9, v11
    v_lshlrev_b32 v10, 16, v19
    v_and_b32 v11, 0xffff0000, v19
    v_add_f32 v9, v9, v10
    v_add_f32 v9, v9, v11
    v_lshlrev_b32 v10, 16, v20
    v_and_b32 v11, 0xffff0000, v20
    v_add_f32 v9, v9, v10
    v_add_f32 v9, v9, v11
    v_lshlrev_b32 v10, 16, v21
    v_and_b32 v11, 0xffff0000, v21
    v_add_f32 v9, v9, v10
    v_add_f32 v9, v9, v11
    v_lshlrev_b32 v10, 16, v22
    v_and_b32 v11, 0xffff0000, v22
    v_add_f32 v9, v9, v10
    v_add_f32 v9, v9, v11
    v_lshlrev_b32 v10, 16, v23
    v_and_b32 v11, 0xffff0000, v23
    v_add_f32 v9, v9, v10
    v_add_f32 v9, v9, v11
    v_mov_b32 v10, v9
    s_nop 1
    v_permlane16_swap_b32 v9, v10
    s_nop 1
    v_add_f32 v9, v9, v10
    v_mov_b32 v10, v9
    s_nop 1
    v_permlane32_swap_b32 v9, v10
    s_nop 1
    v_add_f32 v9, v9, v10
    v_lshlrev_b32 v10, 3, v0
    s_lshl_b32 s83, s76, 6
    v_add_u32 v10, s83, v10
    s_mov_b64 exec, 0xff
    ds_write_b64 v10, v[8:9] offset:59392
    s_mov_b64 exec, -1
    s_nop 1
    s_waitcnt vmcnt(16)
    v_perm_b32 v8, v196, v192, s78
    v_perm_b32 v9, v204, v200, s78
    v_perm_b32 v10, v212, v208, s78
    v_perm_b32 v11, v220, v216, s78
    v_perm_b32 v12, v196, v192, s79
    v_perm_b32 v13, v204, v200, s79
    v_perm_b32 v14, v212, v208, s79
    v_perm_b32 v15, v220, v216, s79
    v_mfma_f32_16x16x32_bf16 v[32:35], v[8:11], v[16:19], 0
    v_perm_b32 v8, v197, v193, s78
    v_perm_b32 v9, v205, v201, s78
    v_perm_b32 v10, v213, v209, s78
    v_perm_b32 v11, v221, v217, s78
    v_mfma_f32_16x16x32_bf16 v[36:39], v[12:15], v[16:19], 0
    v_perm_b32 v12, v197, v193, s79
    v_perm_b32 v13, v205, v201, s79
    v_perm_b32 v14, v213, v209, s79
    v_perm_b32 v15, v221, v217, s79
    v_mfma_f32_16x16x32_bf16 v[40:43], v[8:11], v[16:19], 0
    v_perm_b32 v8, v198, v194, s78
    v_perm_b32 v9, v206, v202, s78
    v_perm_b32 v10, v214, v210, s78
    v_perm_b32 v11, v222, v218, s78
    v_mfma_f32_16x16x32_bf16 v[44:47], v[12:15], v[16:19], 0
    v_perm_b32 v12, v198, v194, s79
    v_perm_b32 v13, v206, v202, s79
    v_perm_b32 v14, v214, v210, s79
    v_perm_b32 v15, v222, v218, s79
    v_mfma_f32_16x16x32_bf16 v[48:51], v[8:11], v[16:19], 0
    v_perm_b32 v8, v199, v195, s78
    v_perm_b32 v9, v207, v203, s78
    v_perm_b32 v10, v215, v211, s78
    v_perm_b32 v11, v223, v219, s78
    v_mfma_f32_16x16x32_bf16 v[52:55], v[12:15], v[16:19], 0
    v_perm_b32 v12, v199, v195, s79
    v_perm_b32 v13, v207, v203, s79
    v_perm_b32 v14, v215, v211, s79
    v_perm_b32 v15, v223, v219, s79
    v_mfma_f32_16x16x32_bf16 v[56:59], v[8:11], v[16:19], 0
    s_nop 1
    v_mfma_f32_16x16x32_bf16 v[60:63], v[12:15], v[16:19], 0
    s_waitcnt vmcnt(0)
    v_perm_b32 v8, v228, v224, s78
    v_perm_b32 v9, v236, v232, s78
    v_perm_b32 v10, v244, v240, s78
    v_perm_b32 v11, v252, v248, s78
    v_perm_b32 v12, v228, v224, s79
    v_perm_b32 v13, v236, v232, s79
    v_perm_b32 v14, v244, v240, s79
    v_perm_b32 v15, v252, v248, s79
    v_mfma_f32_16x16x32_bf16 v[32:35], v[8:11], v[20:23], v[32:35]
    v_perm_b32 v8, v229, v225, s78
    v_perm_b32 v9, v237, v233, s78
    v_perm_b32 v10, v245, v241, s78
    v_perm_b32 v11, v253, v249, s78
    v_mfma_f32_16x16x32_bf16 v[36:39], v[12:15], v[20:23], v[36:39]
    v_perm_b32 v12, v229, v225, s79
    v_perm_b32 v13, v237, v233, s79
    v_perm_b32 v14, v245, v241, s79
    v_perm_b32 v15, v253, v249, s79
    v_mfma_f32_16x16x32_bf16 v[40:43], v[8:11], v[20:23], v[40:43]
    v_perm_b32 v8, v230, v226, s78
    v_perm_b32 v9, v238, v234, s78
    v_perm_b32 v10, v246, v242, s78
    v_perm_b32 v11, v254, v250, s78
    v_mfma_f32_16x16x32_bf16 v[44:47], v[12:15], v[20:23], v[44:47]
    v_perm_b32 v12, v230, v226, s79
    v_perm_b32 v13, v238, v234, s79
    v_perm_b32 v14, v246, v242, s79
    v_perm_b32 v15, v254, v250, s79
    v_mfma_f32_16x16x32_bf16 v[48:51], v[8:11], v[20:23], v[48:51]
    v_perm_b32 v8, v231, v227, s78
    v_perm_b32 v9, v239, v235, s78
    v_perm_b32 v10, v247, v243, s78
    v_perm_b32 v11, v255, v251, s78
    v_mfma_f32_16x16x32_bf16 v[52:55], v[12:15], v[20:23], v[52:55]
    v_perm_b32 v12, v231, v227, s79
    v_perm_b32 v13, v239, v235, s79
    v_perm_b32 v14, v247, v243, s79
    v_perm_b32 v15, v255, v251, s79
    v_mfma_f32_16x16x32_bf16 v[56:59], v[8:11], v[20:23], v[56:59]
    s_nop 1
    v_mfma_f32_16x16x32_bf16 v[60:63], v[12:15], v[20:23], v[60:63]
    s_lshl_b32 s83, s76, 12
    s_add_u32 s83, s83, 61440
    v_lshlrev_b32 v8, 7, v1
    v_lshl_add_u32 v8, v2, 4, v8
    v_add_u32 v8, s83, v8
    s_mov_b64 exec, s[98:99]
    s_nop 5
    ds_write_b128 v8, v[32:35] offset:0
    ds_write_b128 v8, v[36:39] offset:512
    ds_write_b128 v8, v[40:43] offset:1024
    ds_write_b128 v8, v[44:47] offset:1536
    ds_write_b128 v8, v[48:51] offset:2048
    ds_write_b128 v8, v[52:55] offset:2560
    ds_write_b128 v8, v[56:59] offset:3072
    ds_write_b128 v8, v[60:63] offset:3584
    s_mov_b64 exec, -1
    s_waitcnt lgkmcnt(0)
    s_barrier
    s_lshl_b32 s83, s76, 3
    v_mov_b32 v8, s83
    ds_read_b64 v[16:17], v8 offset:59392
    ds_read_b64 v[18:19], v8 offset:59456
    ds_read_b64 v[20:21], v8 offset:59520
    ds_read_b64 v[22:23], v8 offset:59584
    ds_read_b64 v[24:25], v8 offset:59648
    ds_read_b64 v[26:27], v8 offset:59712
    ds_read_b64 v[28:29], v8 offset:59776
    ds_read_b64 v[30:31], v8 offset:59840
    v_lshrrev_b32 v9, 5, v0
    v_bfe_u32 v10, v0, 3, 2
    v_lshlrev_b32 v11, 14, v9
    v_lshl_add_u32 v11, v2, 9, v11
    v_lshl_add_u32 v11, v10, 7, v11
    s_lshl_b32 s83, s76, 4
    s_add_u32 s83, s83, 61440
    v_add_u32 v11, s83, v11
    ds_read_b128 v[32:35], v11 offset:0
    ds_read_b128 v[36:39], v11 offset:4096
    ds_read_b128 v[40:43], v11 offset:8192
    ds_read_b128 v[44:47], v11 offset:12288
    v_mov_b32 v15, 0x3ff
    s_waitcnt lgkmcnt(4)
    v_max3_f32 v48, v16, v18, v20
    v_max3_f32 v48, v48, v22, v24
    v_max3_f32 v48, v48, v26, v28
    v_max_f32 v48, v48, v30
    v_bfi_b32 v48, v15, s92, v48
    v_sub_f32 v52, v16, v48
    v_exp_f32 v52, v52
    v_sub_f32 v53, v18, v48
    v_exp_f32 v53, v53
    v_sub_f32 v54, v20, v48
    v_exp_f32 v54, v54
    v_sub_f32 v55, v22, v48
    v_exp_f32 v55, v55
    v_sub_f32 v56, v24, v48
    v_exp_f32 v56, v56
    v_sub_f32 v57, v26, v48
    v_exp_f32 v57, v57
    v_sub_f32 v58, v28, v48
    v_exp_f32 v58, v58
    v_sub_f32 v59, v30, v48
    v_exp_f32 v59, v59
    s_nop 0
    v_mul_f32 v49, v52, v17
    v_fmac_f32 v49, v53, v19
    v_fmac_f32 v49, v54, v21
    v_fmac_f32 v49, v55, v23
    v_fmac_f32 v49, v56, v25
    v_fmac_f32 v49, v57, v27
    v_fmac_f32 v49, v58, v29
    v_fmac_f32 v49, v59, v31
    v_cmp_lt_u32 vcc, 31, v0
    s_nop 1
    v_cndmask_b32 v52, v52, v56, vcc
    v_cndmask_b32 v53, v53, v57, vcc
    v_cndmask_b32 v54, v54, v58, vcc
    v_cndmask_b32 v55, v55, v59, vcc
    s_waitcnt lgkmcnt(0)
    v_mul_f32 v24, v52, v32
    v_fmac_f32 v24, v53, v36
    v_fmac_f32 v24, v54, v40
    v_fmac_f32 v24, v55, v44
    v_mul_f32 v25, v52, v33
    v_fmac_f32 v25, v53, v37
    v_fmac_f32 v25, v54, v41
    v_fmac_f32 v25, v55, v45
    v_mul_f32 v26, v52, v34
    v_fmac_f32 v26, v53, v38
    v_fmac_f32 v26, v54, v42
    v_fmac_f32 v26, v55, v46
    v_mul_f32 v27, v52, v35
    v_fmac_f32 v27, v53, v39
    v_fmac_f32 v27, v54, v43
    v_fmac_f32 v27, v55, v47
    v_mov_b32 v28, v24
    v_mov_b32 v29, v25
    v_mov_b32 v30, v26
    v_mov_b32 v31, v27
    s_nop 1
    v_permlane32_swap_b32 v24, v28
    v_permlane32_swap_b32 v25, v29
    v_permlane32_swap_b32 v26, v30
    v_permlane32_swap_b32 v27, v31
    s_nop 1
    v_add_f32 v24, v24, v28
    v_add_f32 v25, v25, v29
    v_add_f32 v26, v26, v30
    v_add_f32 v27, v27, v31
    v_cndmask_b32 v24, v24, v48, vcc
    v_cndmask_b32 v25, v25, v49, vcc
    v_cndmask_b32 v26, v26, v48, vcc
    v_cndmask_b32 v27, v27, v49, vcc
    v_lshlrev_b32 v9, 4, v0
    v_min_u32 v9, 512, v9
    v_mov_b32 v15, 0x3ff
    v_bfi_b32 v24, v15, s92, v24
    v_bfi_b32 v25, v15, s93, v25
    v_bfi_b32 v26, v15, s94, v26
    v_bfi_b32 v27, v15, s95, v27
    s_lshr_b32 s82, s2, 3
    s_lshl_b32 s82, s82, 3
    s_add_u32 s82, s82, s76
    s_lshl_b32 s82, s82, 3
    s_and_b32 s83, s2, 7
    s_add_u32 s82, s82, s83
    s_mul_i32 s82, s82, 576
    s_add_u32 s82, s82, 2097152
    s_mov_b32 exec_hi, 1
    buffer_store_dwordx4 v[24:27], v9, s[64:67], s82 offen sc1
    s_mov_b64 exec, -1
    buffer_load_dwordx4 v[64:67], v7, s[56:59], s90 offen offset:0 nt
    buffer_load_dwordx4 v[68:71], v7, s[56:59], s90 offen offset:2048 nt
    s_add_u32 s77, s90, 4096
    buffer_load_dwordx4 v[72:75], v7, s[56:59], s77 offen offset:0 nt
    s_add_u32 s77, s90, 4096
    buffer_load_dwordx4 v[76:79], v7, s[56:59], s77 offen offset:2048 nt
    s_add_u32 s77, s90, 8192
    buffer_load_dwordx4 v[80:83], v7, s[56:59], s77 offen offset:0 nt
    s_add_u32 s77, s90, 8192
    buffer_load_dwordx4 v[84:87], v7, s[56:59], s77 offen offset:2048 nt
    s_add_u32 s77, s90, 12288
    buffer_load_dwordx4 v[88:91], v7, s[56:59], s77 offen offset:0 nt
    s_add_u32 s77, s90, 12288
    buffer_load_dwordx4 v[92:95], v7, s[56:59], s77 offen offset:2048 nt
    v_lshlrev_b32 v6, 8, v2
    v_lshl_add_u32 v6, v1, 4, v6
    s_lshl_b32 s83, s100, 6
    v_add_u32 v6, s83, v6
    s_lshl_b32 s83, s100, 6
    v_add_u32 v12, s83, v0
    v_lshrrev_b32 v9, 5, v12
    v_and_b32 v10, 31, v12
    s_mov_b32 s82, 147456
    v_mul_lo_u32 v13, v9, s82
    v_add_u32 v14, 512, v13
    v_lshl_add_u32 v13, v10, 4, v13
    s_lshr_b32 s86, s2, 3
    s_mul_i32 s86, s86, 4608
    s_add_u32 s86, s86, 2097152
    buffer_load_dwordx4 v[108:111], v14, s[64:67], s86 offen offset:1728 sc1
    buffer_load_dwordx4 v[116:119], v14, s[64:67], s86 offen offset:2880 sc1
    v_bfe_u32 v10, v0, 3, 2
    v_lshlrev_b32 v11, 8, v9
    v_lshl_add_u32 v11, v10, 6, v11
    v_lshl_add_u32 v11, v2, 1, v11
    s_mov_b32 s88, 0
    s_waitcnt vmcnt(0)
Lmg_27:
    v_mov_b32 v8, 0
    v_xor_b32 v12, s92, v108
    v_xor_b32 v15, s93, v109
    v_or3_b32 v8, v8, v12, v15
    v_xor_b32 v12, s94, v110
    v_xor_b32 v15, s95, v111
    v_or3_b32 v8, v8, v12, v15
    v_and_b32 v8, 1023, v8
    v_cmp_ne_u32 vcc, 0, v8
    s_nop 0
    s_mov_b64 s[20:21], vcc
    v_mov_b32 v8, 0
    v_xor_b32 v12, s92, v116
    v_xor_b32 v15, s93, v117
    v_or3_b32 v8, v8, v12, v15
    v_xor_b32 v12, s94, v118
    v_xor_b32 v15, s95, v119
    v_or3_b32 v8, v8, v12, v15
    v_and_b32 v8, 1023, v8
    v_cmp_ne_u32 vcc, 0, v8
    s_nop 0
    s_mov_b64 s[22:23], vcc
    s_or_b64 vcc, s[20:21], s[20:21]
    s_or_b64 vcc, vcc, s[22:23]
    s_cbranch_scc0 Lmgd_28
    s_add_u32 s88, s88, 1
    s_cmp_ge_u32 s88, 100000
    s_cbranch_scc1 Lmgd_28
    s_sleep 8
    s_mov_b64 exec, s[20:21]
    s_cbranch_execz Lmgs_29
    buffer_load_dwordx4 v[108:111], v14, s[64:67], s86 offen offset:1728 sc1
Lmgs_29:
    s_mov_b64 exec, s[22:23]
    s_cbranch_execz Lmgs_30
    buffer_load_dwordx4 v[116:119], v14, s[64:67], s86 offen offset:2880 sc1
Lmgs_30:
    s_mov_b64 exec, -1
    s_waitcnt vmcnt(0)
    s_branch Lmg_27
Lmgd_28:
    buffer_load_dwordx4 v[96:99], v14, s[64:67], s86 offen offset:0 sc1
    buffer_load_dwordx4 v[32:35], v13, s[64:67], s86 offen offset:0 sc1
    buffer_load_dwordx4 v[100:103], v14, s[64:67], s86 offen offset:576 sc1
    buffer_load_dwordx4 v[36:39], v13, s[64:67], s86 offen offset:576 sc1
    buffer_load_dwordx4 v[104:107], v14, s[64:67], s86 offen offset:1152 sc1
    buffer_load_dwordx4 v[40:43], v13, s[64:67], s86 offen offset:1152 sc1
    buffer_load_dwordx4 v[44:47], v13, s[64:67], s86 offen offset:1728 sc1
    buffer_load_dwordx4 v[112:115], v14, s[64:67], s86 offen offset:2304 sc1
    buffer_load_dwordx4 v[48:51], v13, s[64:67], s86 offen offset:2304 sc1
    buffer_load_dwordx4 v[52:55], v13, s[64:67], s86 offen offset:2880 sc1
    buffer_load_dwordx4 v[120:123], v14, s[64:67], s86 offen offset:3456 sc1
    buffer_load_dwordx4 v[56:59], v13, s[64:67], s86 offen offset:3456 sc1
    buffer_load_dwordx4 v[124:127], v14, s[64:67], s86 offen offset:4032 sc1
    buffer_load_dwordx4 v[60:63], v13, s[64:67], s86 offen offset:4032 sc1
    v_perm_b32 v192, v68, v64, s78
    v_perm_b32 v193, v76, v72, s78
    v_perm_b32 v194, v84, v80, s78
    v_perm_b32 v195, v92, v88, s78
    v_perm_b32 v196, v68, v64, s79
    v_perm_b32 v197, v76, v72, s79
    v_perm_b32 v198, v84, v80, s79
    v_perm_b32 v199, v92, v88, s79
    v_perm_b32 v200, v69, v65, s78
    v_perm_b32 v201, v77, v73, s78
    v_perm_b32 v202, v85, v81, s78
    v_perm_b32 v203, v93, v89, s78
    v_perm_b32 v204, v69, v65, s79
    v_perm_b32 v205, v77, v73, s79
    v_perm_b32 v206, v85, v81, s79
    v_perm_b32 v207, v93, v89, s79
    v_perm_b32 v208, v70, v66, s78
    v_perm_b32 v209, v78, v74, s78
    v_perm_b32 v210, v86, v82, s78
    v_perm_b32 v211, v94, v90, s78
    v_perm_b32 v212, v70, v66, s79
    v_perm_b32 v213, v78, v74, s79
    v_perm_b32 v214, v86, v82, s79
    v_perm_b32 v215, v94, v90, s79
    v_perm_b32 v216, v71, v67, s78
    v_perm_b32 v217, v79, v75, s78
    v_perm_b32 v218, v87, v83, s78
    v_perm_b32 v219, v95, v91, s78
    v_perm_b32 v220, v71, v67, s79
    v_perm_b32 v221, v79, v75, s79
    v_perm_b32 v222, v87, v83, s79
    v_perm_b32 v223, v95, v91, s79
    s_mov_b32 s88, 0
    s_waitcnt vmcnt(0)
Lmg_31:
    v_mov_b32 v8, 0
    v_xor_b32 v12, s92, v96
    v_xor_b32 v15, s93, v97
    v_or3_b32 v8, v8, v12, v15
    v_xor_b32 v12, s94, v98
    v_xor_b32 v15, s95, v99
    v_or3_b32 v8, v8, v12, v15
    v_xor_b32 v12, s92, v32
    v_xor_b32 v15, s93, v33
    v_or3_b32 v8, v8, v12, v15
    v_xor_b32 v12, s94, v34
    v_xor_b32 v15, s95, v35
    v_or3_b32 v8, v8, v12, v15
    v_and_b32 v8, 1023, v8
    v_cmp_ne_u32 vcc, 0, v8
    s_nop 0
    s_mov_b64 s[20:21], vcc
    v_mov_b32 v8, 0
    v_xor_b32 v12, s92, v100
    v_xor_b32 v15, s93, v101
    v_or3_b32 v8, v8, v12, v15
    v_xor_b32 v12, s94, v102
    v_xor_b32 v15, s95, v103
    v_or3_b32 v8, v8, v12, v15
    v_xor_b32 v12, s92, v36
    v_xor_b32 v15, s93, v37
    v_or3_b32 v8, v8, v12, v15
    v_xor_b32 v12, s94, v38
    v_xor_b32 v15, s95, v39
    v_or3_b32 v8, v8, v12, v15
    v_and_b32 v8, 1023, v8
    v_cmp_ne_u32 vcc, 0, v8
    s_nop 0
    s_mov_b64 s[22:23], vcc
    v_mov_b32 v8, 0
    v_xor_b32 v12, s92, v104
    v_xor_b32 v15, s93, v105
    v_or3_b32 v8, v8, v12, v15
    v_xor_b32 v12, s94, v106
    v_xor_b32 v15, s95, v107
    v_or3_b32 v8, v8, v12, v15
    v_xor_b32 v12, s92, v40
    v_xor_b32 v15, s93, v41
    v_or3_b32 v8, v8, v12, v15
    v_xor_b32 v12, s94, v42
    v_xor_b32 v15, s95, v43
    v_or3_b32 v8, v8, v12, v15
    v_and_b32 v8, 1023, v8
    v_cmp_ne_u32 vcc, 0, v8
    s_nop 0
    s_mov_b64 s[24:25], vcc
    v_mov_b32 v8, 0
    v_xor_b32 v12, s92, v44
    v_xor_b32 v15, s93, v45
    v_or3_b32 v8, v8, v12, v15
    v_xor_b32 v12, s94, v46
    v_xor_b32 v15, s95, v47
    v_or3_b32 v8, v8, v12, v15
    v_and_b32 v8, 1023, v8
    v_cmp_ne_u32 vcc, 0, v8
    s_nop 0
    s_mov_b64 s[26:27], vcc
    v_mov_b32 v8, 0
    v_xor_b32 v12, s92, v112
    v_xor_b32 v15, s93, v113
    v_or3_b32 v8, v8, v12, v15
    v_xor_b32 v12, s94, v114
    v_xor_b32 v15, s95, v115
    v_or3_b32 v8, v8, v12, v15
    v_xor_b32 v12, s92, v48
    v_xor_b32 v15, s93, v49
    v_or3_b32 v8, v8, v12, v15
    v_xor_b32 v12, s94, v50
    v_xor_b32 v15, s95, v51
    v_or3_b32 v8, v8, v12, v15
    v_and_b32 v8, 1023, v8
    v_cmp_ne_u32 vcc, 0, v8
    s_nop 0
    s_mov_b64 s[28:29], vcc
    v_mov_b32 v8, 0
    v_xor_b32 v12, s92, v52
    v_xor_b32 v15, s93, v53
    v_or3_b32 v8, v8, v12, v15
    v_xor_b32 v12, s94, v54
    v_xor_b32 v15, s95, v55
    v_or3_b32 v8, v8, v12, v15
    v_and_b32 v8, 1023, v8
    v_cmp_ne_u32 vcc, 0, v8
    s_nop 0
    s_mov_b64 s[30:31], vcc
    v_mov_b32 v8, 0
    v_xor_b32 v12, s92, v120
    v_xor_b32 v15, s93, v121
    v_or3_b32 v8, v8, v12, v15
    v_xor_b32 v12, s94, v122
    v_xor_b32 v15, s95, v123
    v_or3_b32 v8, v8, v12, v15
    v_xor_b32 v12, s92, v56
    v_xor_b32 v15, s93, v57
    v_or3_b32 v8, v8, v12, v15
    v_xor_b32 v12, s94, v58
    v_xor_b32 v15, s95, v59
    v_or3_b32 v8, v8, v12, v15
    v_and_b32 v8, 1023, v8
    v_cmp_ne_u32 vcc, 0, v8
    s_nop 0
    s_mov_b64 s[32:33], vcc
    v_mov_b32 v8, 0
    v_xor_b32 v12, s92, v124
    v_xor_b32 v15, s93, v125
    v_or3_b32 v8, v8, v12, v15
    v_xor_b32 v12, s94, v126
    v_xor_b32 v15, s95, v127
    v_or3_b32 v8, v8, v12, v15
    v_xor_b32 v12, s92, v60
    v_xor_b32 v15, s93, v61
    v_or3_b32 v8, v8, v12, v15
    v_xor_b32 v12, s94, v62
    v_xor_b32 v15, s95, v63
    v_or3_b32 v8, v8, v12, v15
    v_and_b32 v8, 1023, v8
    v_cmp_ne_u32 vcc, 0, v8
    s_nop 0
    s_mov_b64 s[34:35], vcc
    s_or_b64 vcc, s[20:21], s[20:21]
    s_or_b64 vcc, vcc, s[22:23]
    s_or_b64 vcc, vcc, s[24:25]
    s_or_b64 vcc, vcc, s[26:27]
    s_or_b64 vcc, vcc, s[28:29]
    s_or_b64 vcc, vcc, s[30:31]
    s_or_b64 vcc, vcc, s[32:33]
    s_or_b64 vcc, vcc, s[34:35]
    s_cbranch_scc0 Lmgd_32
    s_add_u32 s88, s88, 1
    s_cmp_ge_u32 s88, 100000
    s_cbranch_scc1 Lmgd_32
    s_sleep 4
    s_mov_b64 exec, s[20:21]
    s_cbranch_execz Lmgs_33
    buffer_load_dwordx4 v[96:99], v14, s[64:67], s86 offen offset:0 sc1
    buffer_load_dwordx4 v[32:35], v13, s[64:67], s86 offen offset:0 sc1
Lmgs_33:
    s_mov_b64 exec, s[22:23]
    s_cbranch_execz Lmgs_34
    buffer_load_dwordx4 v[100:103], v14, s[64:67], s86 offen offset:576 sc1
    buffer_load_dwordx4 v[36:39], v13, s[64:67], s86 offen offset:576 sc1
Lmgs_34:
    s_mov_b64 exec, s[24:25]
    s_cbranch_execz Lmgs_35
    buffer_load_dwordx4 v[104:107], v14, s[64:67], s86 offen offset:1152 sc1
    buffer_load_dwordx4 v[40:43], v13, s[64:67], s86 offen offset:1152 sc1
Lmgs_35:
    s_mov_b64 exec, s[26:27]
    s_cbranch_execz Lmgs_36
    buffer_load_dwordx4 v[44:47], v13, s[64:67], s86 offen offset:1728 sc1
Lmgs_36:
    s_mov_b64 exec, s[28:29]
    s_cbranch_execz Lmgs_37
    buffer_load_dwordx4 v[112:115], v14, s[64:67], s86 offen offset:2304 sc1
    buffer_load_dwordx4 v[48:51], v13, s[64:67], s86 offen offset:2304 sc1
Lmgs_37:
    s_mov_b64 exec, s[30:31]
    s_cbranch_execz Lmgs_38
    buffer_load_dwordx4 v[52:55], v13, s[64:67], s86 offen offset:2880 sc1
Lmgs_38:
    s_mov_b64 exec, s[32:33]
    s_cbranch_execz Lmgs_39
    buffer_load_dwordx4 v[120:123], v14, s[64:67], s86 offen offset:3456 sc1
    buffer_load_dwordx4 v[56:59], v13, s[64:67], s86 offen offset:3456 sc1
Lmgs_39:
    s_mov_b64 exec, s[34:35]
    s_cbranch_execz Lmgs_40
    buffer_load_dwordx4 v[124:127], v14, s[64:67], s86 offen offset:4032 sc1
    buffer_load_dwordx4 v[60:63], v13, s[64:67], s86 offen offset:4032 sc1
Lmgs_40:
    s_mov_b64 exec, -1
    s_waitcnt vmcnt(0)
    s_branch Lmg_31
Lmgd_32:
    v_max3_f32 v16, v96, v100, v104
    v_max3_f32 v16, v16, v108, v112
    v_max3_f32 v16, v16, v116, v120
    v_max_f32 v16, v16, v124
    v_sub_f32 v24, v96, v16
    v_exp_f32 v24, v24
    v_sub_f32 v25, v100, v16
    v_exp_f32 v25, v25
    v_sub_f32 v26, v104, v16
    v_exp_f32 v26, v26
    v_sub_f32 v27, v108, v16
    v_exp_f32 v27, v27
    v_sub_f32 v28, v112, v16
    v_exp_f32 v28, v28
    v_sub_f32 v29, v116, v16
    v_exp_f32 v29, v29
    v_sub_f32 v30, v120, v16
    v_exp_f32 v30, v30
    v_sub_f32 v31, v124, v16
    v_exp_f32 v31, v31
    s_nop 0
    v_mul_f32 v17, v24, v97
    v_fmac_f32 v17, v25, v101
    v_fmac_f32 v17, v26, v105
    v_fmac_f32 v17, v27, v109
    v_fmac_f32 v17, v28, v113
    v_fmac_f32 v17, v29, v117
    v_fmac_f32 v17, v30, v121
    v_fmac_f32 v17, v31, v125
    v_rcp_f32 v18, v17
    s_nop 0
    v_fma_f32 v19, -v17, v18, 1.0
    v_fma_f32 v18, v19, v18, v18
    v_mul_f32 v20, v24, v32
    v_fmac_f32 v20, v25, v36
    v_fmac_f32 v20, v26, v40
    v_fmac_f32 v20, v27, v44
    v_fmac_f32 v20, v28, v48
    v_fmac_f32 v20, v29, v52
    v_fmac_f32 v20, v30, v56
    v_fmac_f32 v20, v31, v60
    v_mul_f32 v20, v20, v18
    v_mul_f32 v21, v24, v33
    v_fmac_f32 v21, v25, v37
    v_fmac_f32 v21, v26, v41
    v_fmac_f32 v21, v27, v45
    v_fmac_f32 v21, v28, v49
    v_fmac_f32 v21, v29, v53
    v_fmac_f32 v21, v30, v57
    v_fmac_f32 v21, v31, v61
    v_mul_f32 v21, v21, v18
    v_mul_f32 v22, v24, v34
    v_fmac_f32 v22, v25, v38
    v_fmac_f32 v22, v26, v42
    v_fmac_f32 v22, v27, v46
    v_fmac_f32 v22, v28, v50
    v_fmac_f32 v22, v29, v54
    v_fmac_f32 v22, v30, v58
    v_fmac_f32 v22, v31, v62
    v_mul_f32 v22, v22, v18
    v_mul_f32 v23, v24, v35
    v_fmac_f32 v23, v25, v39
    v_fmac_f32 v23, v26, v43
    v_fmac_f32 v23, v27, v47
    v_fmac_f32 v23, v28, v51
    v_fmac_f32 v23, v29, v55
    v_fmac_f32 v23, v30, v59
    v_fmac_f32 v23, v31, v63
    v_mul_f32 v23, v23, v18
    v_cvt_pk_bf16_f32 v8, v20, v21
    v_cvt_pk_bf16_f32 v9, v22, v23
    ds_write_b16 v11, v8 offset:57344
    ds_write_b16_d16_hi v11, v8 offset:57360
    ds_write_b16 v11, v9 offset:57376
    ds_write_b16_d16_hi v11, v9 offset:57392
    s_waitcnt lgkmcnt(0)
    s_barrier
    ds_read_b128 v[16:19], v6 offset:57344
    s_waitcnt vmcnt(0) lgkmcnt(0)
    v_mfma_f32_16x16x32_bf16 v[32:35], v[192:195], v[16:19], 0
    v_mfma_f32_16x16x32_bf16 v[36:39], v[196:199], v[16:19], 0
    v_mfma_f32_16x16x32_bf16 v[40:43], v[200:203], v[16:19], 0
    v_mfma_f32_16x16x32_bf16 v[44:47], v[204:207], v[16:19], 0
    v_mfma_f32_16x16x32_bf16 v[48:51], v[208:211], v[16:19], 0
    v_mfma_f32_16x16x32_bf16 v[52:55], v[212:215], v[16:19], 0
    v_mfma_f32_16x16x32_bf16 v[56:59], v[216:219], v[16:19], 0
    v_mfma_f32_16x16x32_bf16 v[60:63], v[220:223], v[16:19], 0
    s_lshl_b32 s83, s100, 12
    s_add_u32 s83, s83, 0
    v_lshlrev_b32 v8, 7, v1
    v_lshl_add_u32 v8, v2, 4, v8
    v_add_u32 v8, s83, v8
    s_mov_b64 exec, s[98:99]
    s_nop 5
    ds_write_b128 v8, v[32:35] offset:0
    ds_write_b128 v8, v[36:39] offset:512
    ds_write_b128 v8, v[40:43] offset:1024
    ds_write_b128 v8, v[44:47] offset:1536
    ds_write_b128 v8, v[48:51] offset:2048
    ds_write_b128 v8, v[52:55] offset:2560
    ds_write_b128 v8, v[56:59] offset:3072
    ds_write_b128 v8, v[60:63] offset:3584
    s_mov_b64 exec, -1
    s_waitcnt lgkmcnt(0)
    s_barrier
    v_lshrrev_b32 v9, 3, v0
    v_lshlrev_b32 v10, 9, v9
    v_lshl_add_u32 v10, v2, 4, v10
    s_lshl_b32 s83, s100, 7
    v_add_u32 v10, s83, v10
    ds_read_b128 v[32:35], v10 offset:0
    ds_read_b128 v[36:39], v10 offset:4096
    ds_read_b128 v[40:43], v10 offset:8192
    ds_read_b128 v[44:47], v10 offset:12288
    v_lshlrev_b32 v11, 12, v2
    v_lshl_add_u32 v11, v9, 4, v11
    s_lshr_b32 s86, s2, 3
    s_lshl_b32 s86, s86, 15
    s_and_b32 s87, s2, 7
    s_lshl_b32 s87, s87, 9
    s_add_u32 s86, s86, s87
    s_add_u32 s86, s86, s83
    s_add_u32 s86, s86, 4194304
    s_waitcnt lgkmcnt(0)
    v_add_f32 v24, v32, v36
    v_add_f32 v28, v40, v44
    v_add_f32 v24, v24, v28
    v_add_f32 v25, v33, v37
    v_add_f32 v29, v41, v45
    v_add_f32 v25, v25, v29
    v_add_f32 v26, v34, v38
    v_add_f32 v30, v42, v46
    v_add_f32 v26, v26, v30
    v_add_f32 v27, v35, v39
    v_add_f32 v31, v43, v47
    v_add_f32 v27, v27, v31
    v_mov_b32 v15, 0x3ff
    v_bfi_b32 v24, v15, s92, v24
    v_bfi_b32 v25, v15, s93, v25
    v_bfi_b32 v26, v15, s94, v26
    v_bfi_b32 v27, v15, s95, v27
    buffer_store_dwordx4 v[24:27], v11, s[64:67], s86 offen sc1
    s_endpgm
L_b6only:
    s_barrier
L_end:
    s_endpgm
.section .rodata,"a"
.p2align 6
.amdhsa_kernel recurrent_scan__gqa_block_cached__glu_gated_glu__decode_kernel
  .amdhsa_next_free_vgpr 256
  .amdhsa_next_free_sgpr 102
  .amdhsa_accum_offset 256
  .amdhsa_group_segment_fixed_size 0
  .amdhsa_kernarg_size 96
  .amdhsa_user_sgpr_count 2
  .amdhsa_user_sgpr_kernarg_segment_ptr 1
  .amdhsa_system_sgpr_workgroup_id_x 1
.end_amdhsa_kernel
```
